```python
import torch

def _softmax(x, axis=-1):
    return torch.softmax(x, dim=axis)
def _gelu(x):
    return torch.nn.functional.gelu(x, approximate="tanh")
def _silu(x):
    return torch.nn.functional.silu(x)
def _sigmoid(x):
    return torch.sigmoid(x)
def _layernorm(x, axis=-1, eps=1e-5):
    m = x.mean(dim=axis, keepdim=True)
    v = x.var(dim=axis, keepdim=True, unbiased=False)
    return (x - m) / torch.sqrt(v + eps)
def _scatter_add(tgt, idx, src, axis=0):
    return tgt.clone().index_add_(axis, idx, src)
def _segment_sum(src, seg, n):
    out = torch.zeros((n,) + src.shape[1:], dtype=src.dtype)
    return out.index_add_(0, seg, src)
def _pad(x, pw):
    flat = tuple(v for pair in reversed(pw) for v in pair)
    return torch.nn.functional.pad(x, flat)

kernel_name = 'recurrent_scan__mha_block__mixer_channel_mlp__prompt'

def setup_inputs():

    _w = (lambda a: (lambda t: t.to(torch.bfloat16) if t.is_floating_point() else t)(torch.as_tensor(a)))
    def _A_setup():
        B, S, D, H = 1, 2048, 512, 32
        return {
            "x": _w((lambda *s: torch.randn(*s, dtype=torch.bfloat16) * 0.05)(B, S, D)),
            "wqkv": _w((lambda *s: torch.randn(*s, dtype=torch.bfloat16) * 0.1)(D, 3 * D)),
            "wo": _w((lambda *s: torch.randn(*s, dtype=torch.bfloat16) * 0.05)(D, D)),
        }
    _A_in = _A_setup()

    def _B_setup():
        B, S, D, F = 1, 2048, 512, 1792
        return {
            "x": _w((lambda *s: torch.randn(*s, dtype=torch.bfloat16) * 0.05)(B, S, D)),
            "w1": _w((lambda *s: torch.randn(*s, dtype=torch.bfloat16) * 3.2)(D, F) * (D ** -0.5)),
            "b1": _w((lambda *s: torch.randn(*s, dtype=torch.bfloat16) * 1.6)(F)),
            "w2": _w((lambda *s: torch.randn(*s, dtype=torch.bfloat16) * 0.8)(F, D) * (F ** -0.5)),
            "b2": _w((lambda *s: torch.randn(*s, dtype=torch.bfloat16) * 0.8)(D)),
        }
    _B_in = _B_setup()

    return {
        "A_x": _A_in["x"],
        "A_wqkv": _A_in["wqkv"],
        "A_wo": _A_in["wo"],
        "B_x": _B_in["x"],
        "B_w1": _B_in["w1"],
        "B_b1": _B_in["b1"],
        "B_w2": _B_in["w2"],
        "B_b2": _B_in["b2"],
    }

def reference(A_x, A_wqkv, A_wo, B_x, B_w1, B_b1, B_w2, B_b2):
    def _A_ref(x, wqkv, wo):
        B, S, D = x.shape
        H = 32
        Dh = D // H
        qkv = (lambda x, *d: x.permute(*d))((x @ wqkv).reshape(B, S, 3, H, Dh), 2, 0, 3, 1, 4)
        q, k, v = qkv[0], qkv[1], qkv[2]
        scores = torch.einsum("bhqd,bhkd->bhqk", q, k) * (Dh ** -0.5)
        p = _softmax(scores, axis=-1)
        o = torch.einsum("bhqk,bhkd->bhqd", p, v)
        return (lambda x, *d: x.permute(*d))(o, 0, 2, 1, 3).reshape(B, S, D) @ wo

    def _B_ref(x, w1, b1, w2, b2):
        y = _layernorm(x, axis=-1)
        h = _gelu(torch.einsum("bsd,df->bsf", y, w1) + b1)
        return torch.einsum("bsf,fd->bsd", h, w2) + b2

    x = A_x
    xn = _layernorm(x, axis=-1)
    s = _A_ref(xn, A_wqkv, A_wo)
    g = _silu(_B_ref(xn, B_w1, B_b1, B_w2, B_b2))
    return x + s * g
```

```asm
; @launch grid=(256,1,1) block=(512,1,1) lds=163840
.amdgcn_target "amdgcn-amd-amdhsa--gfx950"
.text
.globl recurrent_scan__mha_block__mixer_channel_mlp__prompt_kernel
.p2align 8
.type recurrent_scan__mha_block__mixer_channel_mlp__prompt_kernel,@function
recurrent_scan__mha_block__mixer_channel_mlp__prompt_kernel:
    s_cmp_ge_u32 s2, 256
    s_cbranch_scc1 L_exit
    s_load_dwordx2 s[4:5], s[0:1], 0
    s_load_dwordx2 s[8:9], s[0:1], 8
    s_load_dwordx2 s[16:17], s[0:1], 32
    s_load_dwordx2 s[36:37], s[0:1], 80
    s_load_dwordx2 s[20:21], s[0:1], 40
    s_load_dwordx2 s[12:13], s[0:1], 16
    s_load_dwordx2 s[24:25], s[0:1], 48
    s_load_dwordx2 s[28:29], s[0:1], 56
    s_load_dwordx2 s[32:33], s[0:1], 64
    v_lshrrev_b32 v1, 6, v0
    v_and_b32 v0, 63, v0
    v_readfirstlane_b32 s42, v1
    s_mov_b32 s6, 0x200000
    s_mov_b32 s7, 0x20000
    s_mov_b32 s10, 0x180000
    s_mov_b32 s11, 0x20000
    s_mov_b32 s18, 0x1c0000
    s_mov_b32 s19, 0x20000
    s_and_b32 s45, s2, 7
    s_lshr_b32 s46, s2, 3
    s_and_b32 s43, s42, 3
    s_lshr_b32 s44, s42, 2
    s_getpc_b64 s[56:57]
L_pc_1:
    s_sub_u32 s56, s56, L_pc_1-recurrent_scan__mha_block__mixer_channel_mlp__prompt_kernel
    s_subb_u32 s57, s57, 0
    s_lshl_b32 s51, s46, 3
    s_add_u32 s51, s51, s42
    s_lshl_b32 s51, s51, 7
    v_lshl_add_u32 v208, v0, 15, s51
    v_min_u32 v208, L_codeend-recurrent_scan__mha_block__mixer_channel_mlp__prompt_kernel-4, v208
    s_mov_b64 exec, 3
    global_load_dword v211, v208, s[56:57]
    s_mov_b64 exec, -1
    s_and_b32 s50, s45, 1
    s_lshl_b32 s50, s50, 3
    s_and_b32 s69, s46, 7
    s_add_u32 s47, s50, s69
    s_and_b32 s50, s45, 6
    s_lshr_b32 s51, s46, 4
    s_add_u32 s48, s50, s51
    s_lshr_b32 s50, s46, 3
    s_lshl_b32 s50, s50, 1
    s_add_u32 s40, s50, s69
    s_and_b32 s40, s40, 4
    s_lshl_b32 s66, s42, 11
    s_lshl_b32 s67, s42, 10
    v_lshrrev_b32 v212, 3, v0
    v_and_b32 v213, 7, v0
    v_lshrrev_b32 v214, 4, v0
    v_xor_b32 v215, v213, v214
    s_lshl_b32 s50, s47, 17
    s_lshl_b32 s51, s42, 14
    s_add_u32 s50, s50, s51
    v_lshlrev_b32 v216, 10, v212
    v_add_u32 v216, s50, v216
    v_lshl_add_u32 v238, v215, 4, v216
    v_xor_b32 v215, 4, v215
    v_lshl_add_u32 v239, v215, 4, v216
    v_add_u32 v239, 7168, v239
    v_and_b32 v214, 1, v214
    v_lshlrev_b32 v214, 2, v214
    v_xor_b32 v217, v213, v214
    v_lshlrev_b32 v217, 4, v217
    s_lshl_b32 s50, s42, 3
    v_add_u32 v212, s50, v212
    s_mul_i32 s73, s48, 448
    s_and_b32 s50, s48, 1
    s_lshl_b32 s51, s50, 6
    s_add_u32 s74, s73, s51
    s_xor_b32 s50, s50, 1
    s_mul_i32 s50, s50, 384
    s_add_u32 s73, s73, s50
    s_lshl_b32 s53, s48, 7
    s_bitcmp1_b32 s46, 3
    s_cbranch_scc1 L_typeB_2
    v_mul_u32_u24 v240, 3072, v212
    v_add3_u32 v240, v240, v217, s53
    v_add_u32 v241, 1024, v240
    s_add_u32 s75, s74, 256
    s_waitcnt lgkmcnt(0)
    s_add_u32 m0, s66, 0x0
    s_add_u32 s41, s40, 0
    s_and_b32 s41, s41, 7
    s_mul_i32 s52, s41, 0x80
    buffer_load_dwordx4 v238, s[4:7], s52 offen lds
    s_add_u32 m0, s66, 0x0
    s_mul_i32 s52, s41, 0x80
    buffer_load_dwordx4 v239, s[4:7], s52 offen offset:1024 lds
    s_add_u32 m0, s67, 0x4000
    s_mul_i32 s52, s41, 0x30000
    buffer_load_dwordx4 v240, s[8:11], s52 offen lds
    s_add_u32 m0, s67, 0x6000
    s_mul_i32 s52, s41, 0x30000
    buffer_load_dwordx4 v241, s[8:11], s52 offen lds
    s_mov_b32 s38, 0x1900000
    s_mov_b32 s39, 0x20000
    s_mov_b32 s22, 0xe00
    s_mov_b32 s23, 0x20000
    s_mov_b32 s14, 0x80000
    s_mov_b32 s15, 0x20000
    s_mov_b32 s26, 0x1c0000
    s_mov_b32 s27, 0x20000
    s_mov_b32 s30, 0x400
    s_mov_b32 s31, 0x20000
    s_mov_b32 s34, 0x200000
    s_mov_b32 s35, 0x20000
    s_barrier
    s_mov_b32 s52, 0x1800000
    buffer_load_dword v228, off, s[36:39], s52 sc1
    s_lshl_b32 s50, s48, 4
    s_add_u32 s50, s50, s42
    s_lshl_b32 s51, s47, 7
    s_add_u32 s50, s50, s51
    s_add_u32 s60, s50, 0
    s_lshl_b32 s52, s60, 10
    v_lshlrev_b32 v254, 4, v0
    buffer_load_dwordx4 v[220:223], v254, s[4:7], s52 offen
    s_add_u32 m0, s66, 0x8000
    s_add_u32 s41, s40, 1
    s_and_b32 s41, s41, 7
    s_mul_i32 s52, s41, 0x80
    buffer_load_dwordx4 v238, s[4:7], s52 offen lds
    s_add_u32 m0, s66, 0x8000
    s_mul_i32 s52, s41, 0x80
    buffer_load_dwordx4 v239, s[4:7], s52 offen offset:1024 lds
    s_add_u32 m0, s67, 0xc000
    s_mul_i32 s52, s41, 0x30000
    buffer_load_dwordx4 v240, s[8:11], s52 offen lds
    s_add_u32 m0, s67, 0xe000
    s_mul_i32 s52, s41, 0x30000
    buffer_load_dwordx4 v241, s[8:11], s52 offen lds
    s_branch L_mainA_4
L_typeB_2:
    s_add_u32 s53, s53, 2048
    v_mul_u32_u24 v240, 3072, v212
    v_add3_u32 v240, v240, v217, s53
    v_mul_u32_u24 v241, 3584, v212
    v_add3_u32 v241, v241, v217, s74
    s_add_u32 s75, s74, 128
    s_waitcnt lgkmcnt(0)
    s_add_u32 m0, s66, 0x0
    s_add_u32 s41, s40, 0
    s_and_b32 s41, s41, 7
    s_mul_i32 s52, s41, 0x80
    buffer_load_dwordx4 v238, s[4:7], s52 offen lds
    s_add_u32 m0, s66, 0x0
    s_mul_i32 s52, s41, 0x80
    buffer_load_dwordx4 v239, s[4:7], s52 offen offset:1024 lds
    s_add_u32 m0, s67, 0x4000
    s_mul_i32 s52, s41, 0x30000
    buffer_load_dwordx4 v240, s[8:11], s52 offen lds
    s_add_u32 m0, s67, 0x6000
    s_mul_i32 s52, s41, 0x38000
    buffer_load_dwordx4 v241, s[16:19], s52 offen lds
    s_mov_b32 s38, 0x1900000
    s_mov_b32 s39, 0x20000
    s_mov_b32 s22, 0xe00
    s_mov_b32 s23, 0x20000
    s_mov_b32 s14, 0x80000
    s_mov_b32 s15, 0x20000
    s_mov_b32 s26, 0x1c0000
    s_mov_b32 s27, 0x20000
    s_mov_b32 s30, 0x400
    s_mov_b32 s31, 0x20000
    s_mov_b32 s34, 0x200000
    s_mov_b32 s35, 0x20000
    s_barrier
    s_mov_b32 s52, 0x1800000
    buffer_load_dword v228, off, s[36:39], s52 sc1
    s_lshl_b32 s50, s48, 4
    s_add_u32 s50, s50, s42
    s_lshl_b32 s51, s47, 7
    s_add_u32 s50, s50, s51
    s_add_u32 s60, s50, 8
    s_lshl_b32 s52, s60, 10
    v_lshlrev_b32 v254, 4, v0
    buffer_load_dwordx4 v[220:223], v254, s[4:7], s52 offen
    s_add_u32 m0, s66, 0x8000
    s_add_u32 s41, s40, 1
    s_and_b32 s41, s41, 7
    s_mul_i32 s52, s41, 0x80
    buffer_load_dwordx4 v238, s[4:7], s52 offen lds
    s_add_u32 m0, s66, 0x8000
    s_mul_i32 s52, s41, 0x80
    buffer_load_dwordx4 v239, s[4:7], s52 offen offset:1024 lds
    s_add_u32 m0, s67, 0xc000
    s_mul_i32 s52, s41, 0x30000
    buffer_load_dwordx4 v240, s[8:11], s52 offen lds
    s_add_u32 m0, s67, 0xe000
    s_mul_i32 s52, s41, 0x38000
    buffer_load_dwordx4 v241, s[16:19], s52 offen lds
    s_branch L_mainB_5
L_mainA_4:
    v_mul_u32_u24 v242, 3584, v212
    v_add3_u32 v242, v242, v217, s75
    v_lshrrev_b32 v212, 2, v0
    s_lshl_b32 s50, s43, 4
    v_add_u32 v212, s50, v212
    v_and_b32 v217, 3, v0
    v_lshlrev_b32 v217, 4, v217
    v_mul_u32_u24 v243, 3584, v212
    v_add3_u32 v243, v243, v217, s73
    v_and_b32 v212, 31, v0
    v_lshlrev_b32 v212, 1, v212
    s_lshl_b32 s50, s44, 6
    s_add_u32 s74, s75, s50
    s_mov_b32 s75, s73
    buffer_load_ushort v249, v212, s[20:23], s74 offen
    buffer_load_ushort v251, v212, s[20:23], s75 offen
    s_lshl_b32 s50, s44, 1
    s_xor_b32 s49, s43, s50
    v_and_b32 v212, 31, v0
    v_lshrrev_b32 v213, 5, v0
    v_bfe_u32 v214, v0, 1, 3
    v_xor_b32 v214, v214, v213
    s_lshl_b32 s50, s49, 1
    v_xor_b32 v214, s50, v214
    v_lshlrev_b32 v214, 4, v214
    v_lshl_add_u32 v214, v212, 7, v214
    s_lshl_b32 s50, s43, 12
    v_add_u32 v192, s50, v214
    v_xor_b32 v193, 32, v192
    v_xor_b32 v194, 64, v192
    v_xor_b32 v195, 96, v192
    v_bfe_u32 v214, v0, 2, 2
    v_lshl_add_u32 v215, v213, 3, v214
    v_lshrrev_b32 v214, 1, v214
    v_xor_b32 v214, s44, v214
    v_lshlrev_b32 v214, 6, v214
    v_lshl_add_u32 v214, v215, 7, v214
    v_bfe_u32 v216, v0, 4, 1
    v_lshl_add_u32 v214, v216, 5, v214
    v_and_b32 v217, 3, v0
    v_lshl_add_u32 v214, v217, 3, v214
    s_lshl_b32 s50, s49, 11
    v_add_u32 v2, s50, v214
    v_xor_b32 v3, 2048, v2
    v_xor_b32 v236, 4096, v2
    v_xor_b32 v237, 6144, v2
    v_bfe_u32 v214, v0, 2, 1
    v_xor_b32 v214, v214, v216
    v_or_b32 v214, v214, v217
    v_cmp_eq_u32 vcc, 0, v214
    v_mov_b32 v215, 0x3f003f00
    s_nop 0
    v_cndmask_b32 v200, 0, v215, vcc
    v_mov_b32 v201, v200
    v_mov_b32 v202, v200
    v_mov_b32 v203, v200
    s_mov_b32 s59, 0xffff0000
    s_mov_b32 s62, 0x03020302
    s_mov_b32 s63, 0x07060302
    s_mov_b32 s64, 0x01000100
    v_lshlrev_b32 v255, 2, v0
    v_mov_b32 v214, 151552
    v_mov_b32 v215, 0
    ds_write_b32 v214, v215
    s_lshr_b32 s71, s46, 3
    s_lshl_b32 s68, s45, 2
    s_add_u32 s68, s68, s71
    s_lshl_b32 s70, s69, 3
    s_add_u32 s70, s70, s45
    s_waitcnt vmcnt(8)
    s_barrier
    ds_read_b128 v[4:7], v192 offset:0
    ds_read_b64_tr_b16 v[164:165], v2 offset:16384
    ds_read_b64_tr_b16 v[166:167], v2 offset:16896
    ds_read_b64_tr_b16 v[168:169], v2 offset:24576
    ds_read_b64_tr_b16 v[170:171], v2 offset:25088
    ds_read_b128 v[8:11], v193 offset:0
    ds_read_b64_tr_b16 v[172:173], v3 offset:16384
    ds_read_b64_tr_b16 v[174:175], v3 offset:16896
    ds_read_b64_tr_b16 v[176:177], v3 offset:24576
    ds_read_b64_tr_b16 v[178:179], v3 offset:25088
    s_waitcnt lgkmcnt(5)
    v_mfma_f32_32x32x16_bf16 v[132:147], v[164:167], v[4:7], 0
    ds_read_b128 v[12:15], v194 offset:0
    ds_read_b64_tr_b16 v[212:213], v236 offset:16384
    ds_read_b64_tr_b16 v[214:215], v236 offset:16896
    v_mfma_f32_16x16x32_bf16 v[196:199], v[200:203], v[164:167], 0
    v_mfma_f32_32x32x16_bf16 v[148:163], v[168:171], v[4:7], 0
    ds_read_b64_tr_b16 v[216:217], v236 offset:24576
    ds_read_b64_tr_b16 v[218:219], v236 offset:25088
    s_add_u32 m0, s66, 0x10000
    s_add_u32 s41, s40, 2
    s_and_b32 s41, s41, 7
    s_mul_i32 s52, s41, 0x80
    buffer_load_dwordx4 v238, s[4:7], s52 offen lds
    s_add_u32 m0, s66, 0x10000
    s_mul_i32 s52, s41, 0x80
    buffer_load_dwordx4 v239, s[4:7], s52 offen offset:1024 lds
    v_mfma_f32_16x16x32_bf16 v[188:191], v[200:203], v[168:171], 0
    s_waitcnt lgkmcnt(5)
    v_mfma_f32_32x32x16_bf16 v[132:147], v[172:175], v[8:11], v[132:147]
    ds_read_b128 v[16:19], v195 offset:0
    ds_read_b64_tr_b16 v[164:165], v237 offset:16384
    ds_read_b64_tr_b16 v[166:167], v237 offset:16896
    v_mfma_f32_32x32x16_bf16 v[148:163], v[176:179], v[8:11], v[148:163]
    ds_read_b64_tr_b16 v[168:169], v237 offset:24576
    ds_read_b64_tr_b16 v[170:171], v237 offset:25088
    s_add_u32 m0, s67, 0x14000
    s_mul_i32 s52, s41, 0x30000
    buffer_load_dwordx4 v240, s[8:11], s52 offen lds
    s_add_u32 m0, s67, 0x16000
    s_mul_i32 s52, s41, 0x30000
    buffer_load_dwordx4 v241, s[8:11], s52 offen lds
    s_waitcnt lgkmcnt(5)
    v_mfma_f32_32x32x16_bf16 v[132:147], v[212:215], v[12:15], v[132:147]
    s_waitcnt vmcnt(6)
    s_barrier
    ds_read_b128 v[20:23], v192 offset:32768
    ds_read_b64_tr_b16 v[172:173], v2 offset:49152
    ds_read_b64_tr_b16 v[174:175], v2 offset:49664
    v_mfma_f32_32x32x16_bf16 v[148:163], v[216:219], v[12:15], v[148:163]
    ds_read_b64_tr_b16 v[176:177], v2 offset:57344
    ds_read_b64_tr_b16 v[178:179], v2 offset:57856
    s_add_u32 m0, s66, 0x18000
    s_add_u32 s41, s40, 3
    s_and_b32 s41, s41, 7
    s_mul_i32 s52, s41, 0x80
    buffer_load_dwordx4 v238, s[4:7], s52 offen lds
    s_waitcnt lgkmcnt(5)
    v_mfma_f32_32x32x16_bf16 v[132:147], v[164:167], v[16:19], v[132:147]
    ds_read_b128 v[24:27], v193 offset:32768
    ds_read_b64_tr_b16 v[212:213], v3 offset:49152
    ds_read_b64_tr_b16 v[214:215], v3 offset:49664
    v_readfirstlane_b32 s78, v228
    v_lshlrev_b32 v229, 16, v220
    v_and_b32 v230, s59, v220
    v_add_f32 v224, v229, v230
    v_mfma_f32_32x32x16_bf16 v[148:163], v[168:171], v[16:19], v[148:163]
    ds_read_b64_tr_b16 v[216:217], v3 offset:57344
    ds_read_b64_tr_b16 v[218:219], v3 offset:57856
    s_add_u32 m0, s66, 0x18000
    s_mul_i32 s52, s41, 0x80
    buffer_load_dwordx4 v239, s[4:7], s52 offen offset:1024 lds
    v_mul_f32 v226, v229, v229
    s_add_u32 s78, s78, 1
    v_fmac_f32 v226, v230, v230
    v_lshlrev_b32 v229, 16, v221
    s_waitcnt lgkmcnt(5)
    v_mfma_f32_32x32x16_bf16 v[132:147], v[172:175], v[20:23], v[132:147]
    ds_read_b128 v[28:31], v194 offset:32768
    ds_read_b64_tr_b16 v[164:165], v236 offset:49152
    ds_read_b64_tr_b16 v[166:167], v236 offset:49664
    v_and_b32 v230, s59, v221
    v_add_f32 v224, v224, v229
    v_fmac_f32 v226, v229, v229
    v_add_f32 v224, v224, v230
    v_mfma_f32_16x16x32_bf16 v[196:199], v[200:203], v[172:175], v[196:199]
    v_mfma_f32_32x32x16_bf16 v[148:163], v[176:179], v[20:23], v[148:163]
    ds_read_b64_tr_b16 v[168:169], v236 offset:57344
    ds_read_b64_tr_b16 v[170:171], v236 offset:57856
    s_add_u32 m0, s67, 0x1c000
    s_mul_i32 s52, s41, 0x30000
    buffer_load_dwordx4 v240, s[8:11], s52 offen lds
    v_fmac_f32 v226, v230, v230
    v_lshlrev_b32 v229, 16, v222
    v_and_b32 v230, s59, v222
    v_add_f32 v224, v224, v229
    v_mfma_f32_16x16x32_bf16 v[188:191], v[200:203], v[176:179], v[188:191]
    s_waitcnt lgkmcnt(5)
    v_mfma_f32_32x32x16_bf16 v[132:147], v[212:215], v[24:27], v[132:147]
    ds_read_b128 v[32:35], v195 offset:32768
    ds_read_b64_tr_b16 v[172:173], v237 offset:49152
    ds_read_b64_tr_b16 v[174:175], v237 offset:49664
    v_fmac_f32 v226, v229, v229
    v_add_f32 v224, v224, v230
    v_fmac_f32 v226, v230, v230
    v_lshlrev_b32 v229, 16, v223
    v_mfma_f32_32x32x16_bf16 v[148:163], v[216:219], v[24:27], v[148:163]
    ds_read_b64_tr_b16 v[176:177], v237 offset:57344
    ds_read_b64_tr_b16 v[178:179], v237 offset:57856
    s_add_u32 m0, s67, 0x1e000
    s_mul_i32 s52, s41, 0x30000
    buffer_load_dwordx4 v241, s[8:11], s52 offen lds
    v_and_b32 v230, s59, v223
    v_add_f32 v224, v224, v229
    v_fmac_f32 v226, v229, v229
    v_add_f32 v224, v224, v230
    s_waitcnt lgkmcnt(5)
    v_mfma_f32_32x32x16_bf16 v[132:147], v[164:167], v[28:31], v[132:147]
    s_waitcnt vmcnt(4)
    s_barrier
    v_add_u32 v192, 0x10000, v192
    v_add_u32 v193, 0x10000, v193
    v_add_u32 v194, 0x10000, v194
    v_add_u32 v195, 0x10000, v195
    v_add_u32 v2, 0x10000, v2
    v_add_u32 v3, 0x10000, v3
    v_add_u32 v236, 0x10000, v236
    v_add_u32 v237, 0x10000, v237
    ds_read_b128 v[36:39], v192 offset:0
    ds_read_b64_tr_b16 v[212:213], v2 offset:16384
    ds_read_b64_tr_b16 v[214:215], v2 offset:16896
    v_fmac_f32 v226, v230, v230
    v_mov_b32 v225, s78
    v_add_f32_dpp v224, v224, v224 row_shr:1 row_mask:0xf bank_mask:0xf bound_ctrl:1
    v_add_f32_dpp v226, v226, v226 row_shr:1 row_mask:0xf bank_mask:0xf bound_ctrl:1
    v_mfma_f32_32x32x16_bf16 v[148:163], v[168:171], v[28:31], v[148:163]
    ds_read_b64_tr_b16 v[216:217], v2 offset:24576
    ds_read_b64_tr_b16 v[218:219], v2 offset:25088
    s_add_u32 m0, s66, 0x0
    s_add_u32 s41, s40, 4
    s_and_b32 s41, s41, 7
    s_mul_i32 s52, s41, 0x80
    buffer_load_dwordx4 v238, s[4:7], s52 offen lds
    v_mov_b32 v227, s78
    v_add_f32_dpp v224, v224, v224 row_shr:2 row_mask:0xf bank_mask:0xf bound_ctrl:1
    v_add_f32_dpp v226, v226, v226 row_shr:2 row_mask:0xf bank_mask:0xf bound_ctrl:1
    s_lshl_b32 s60, s60, 4
    s_waitcnt lgkmcnt(5)
    v_mfma_f32_32x32x16_bf16 v[132:147], v[172:175], v[32:35], v[132:147]
    ds_read_b128 v[40:43], v193 offset:0
    ds_read_b64_tr_b16 v[164:165], v3 offset:16384
    ds_read_b64_tr_b16 v[166:167], v3 offset:16896
    v_add_f32_dpp v224, v224, v224 row_shr:4 row_mask:0xf bank_mask:0xf bound_ctrl:1
    v_add_f32_dpp v226, v226, v226 row_shr:4 row_mask:0xf bank_mask:0xf bound_ctrl:1
    s_add_u32 s60, s60, 0x1300000
    v_add_f32_dpp v224, v224, v224 row_shr:8 row_mask:0xf bank_mask:0xf bound_ctrl:1
    v_mfma_f32_32x32x16_bf16 v[148:163], v[176:179], v[32:35], v[148:163]
    ds_read_b64_tr_b16 v[168:169], v3 offset:24576
    ds_read_b64_tr_b16 v[170:171], v3 offset:25088
    s_add_u32 m0, s66, 0x0
    s_mul_i32 s52, s41, 0x80
    buffer_load_dwordx4 v239, s[4:7], s52 offen offset:1024 lds
    v_add_f32_dpp v226, v226, v226 row_shr:8 row_mask:0xf bank_mask:0xf bound_ctrl:1
    s_nop 0
    v_add_f32_dpp v224, v224, v224 row_bcast:15 row_mask:0xa bank_mask:0xf
    v_add_f32_dpp v226, v226, v226 row_bcast:15 row_mask:0xa bank_mask:0xf
    s_waitcnt lgkmcnt(5)
    v_mfma_f32_32x32x16_bf16 v[132:147], v[212:215], v[36:39], v[132:147]
    ds_read_b128 v[44:47], v194 offset:0
    ds_read_b64_tr_b16 v[172:173], v236 offset:16384
    ds_read_b64_tr_b16 v[174:175], v236 offset:16896
    s_nop 0
    v_add_f32_dpp v224, v224, v224 row_bcast:31 row_mask:0xc bank_mask:0xf
    v_add_f32_dpp v226, v226, v226 row_bcast:31 row_mask:0xc bank_mask:0xf
    v_mfma_f32_16x16x32_bf16 v[196:199], v[200:203], v[212:215], v[196:199]
    v_mfma_f32_32x32x16_bf16 v[148:163], v[216:219], v[36:39], v[148:163]
    ds_read_b64_tr_b16 v[176:177], v236 offset:24576
    ds_read_b64_tr_b16 v[178:179], v236 offset:25088
    s_add_u32 m0, s67, 0x4000
    s_mul_i32 s52, s41, 0x30000
    buffer_load_dwordx4 v240, s[8:11], s52 offen lds
    v_mfma_f32_16x16x32_bf16 v[188:191], v[200:203], v[216:219], v[188:191]
    s_mov_b32 exec_lo, 0
    s_mov_b32 exec_hi, 0x80000000
    buffer_store_dwordx4 v[224:227], off, s[36:39], s60 sc1
    s_mov_b64 exec, -1
    s_waitcnt lgkmcnt(5)
    v_mfma_f32_32x32x16_bf16 v[132:147], v[164:167], v[40:43], v[132:147]
    ds_read_b128 v[48:51], v195 offset:0
    ds_read_b64_tr_b16 v[212:213], v237 offset:16384
    ds_read_b64_tr_b16 v[214:215], v237 offset:16896
    v_mfma_f32_32x32x16_bf16 v[148:163], v[168:171], v[40:43], v[148:163]
    ds_read_b64_tr_b16 v[216:217], v237 offset:24576
    ds_read_b64_tr_b16 v[218:219], v237 offset:25088
    s_add_u32 m0, s67, 0x6000
    s_mul_i32 s52, s41, 0x30000
    buffer_load_dwordx4 v241, s[8:11], s52 offen lds
    s_waitcnt lgkmcnt(5)
    v_mfma_f32_32x32x16_bf16 v[132:147], v[172:175], v[44:47], v[132:147]
    s_waitcnt vmcnt(5)
    s_barrier
    ds_read_b128 v[52:55], v192 offset:32768
    ds_read_b64_tr_b16 v[164:165], v2 offset:49152
    ds_read_b64_tr_b16 v[166:167], v2 offset:49664
    v_mfma_f32_32x32x16_bf16 v[148:163], v[176:179], v[44:47], v[148:163]
    ds_read_b64_tr_b16 v[168:169], v2 offset:57344
    ds_read_b64_tr_b16 v[170:171], v2 offset:57856
    s_add_u32 m0, s66, 0x8000
    s_add_u32 s41, s40, 5
    s_and_b32 s41, s41, 7
    s_mul_i32 s52, s41, 0x80
    buffer_load_dwordx4 v238, s[4:7], s52 offen lds
    s_waitcnt lgkmcnt(5)
    v_mfma_f32_32x32x16_bf16 v[132:147], v[212:215], v[48:51], v[132:147]
    ds_read_b128 v[56:59], v193 offset:32768
    ds_read_b64_tr_b16 v[172:173], v3 offset:49152
    ds_read_b64_tr_b16 v[174:175], v3 offset:49664
    v_mfma_f32_32x32x16_bf16 v[148:163], v[216:219], v[48:51], v[148:163]
    ds_read_b64_tr_b16 v[176:177], v3 offset:57344
    ds_read_b64_tr_b16 v[178:179], v3 offset:57856
    s_add_u32 m0, s66, 0x8000
    s_mul_i32 s52, s41, 0x80
    buffer_load_dwordx4 v239, s[4:7], s52 offen offset:1024 lds
    s_waitcnt lgkmcnt(5)
    v_mfma_f32_32x32x16_bf16 v[132:147], v[164:167], v[52:55], v[132:147]
    ds_read_b128 v[60:63], v194 offset:32768
    ds_read_b64_tr_b16 v[212:213], v236 offset:49152
    ds_read_b64_tr_b16 v[214:215], v236 offset:49664
    v_mfma_f32_16x16x32_bf16 v[196:199], v[200:203], v[164:167], v[196:199]
    v_mfma_f32_32x32x16_bf16 v[148:163], v[168:171], v[52:55], v[148:163]
    ds_read_b64_tr_b16 v[216:217], v236 offset:57344
    ds_read_b64_tr_b16 v[218:219], v236 offset:57856
    s_add_u32 m0, s67, 0xc000
    s_mul_i32 s52, s41, 0x30000
    buffer_load_dwordx4 v240, s[8:11], s52 offen lds
    v_mfma_f32_16x16x32_bf16 v[188:191], v[200:203], v[168:171], v[188:191]
    s_waitcnt lgkmcnt(5)
    v_mfma_f32_32x32x16_bf16 v[132:147], v[172:175], v[56:59], v[132:147]
    ds_read_b128 v[64:67], v195 offset:32768
    ds_read_b64_tr_b16 v[164:165], v237 offset:49152
    ds_read_b64_tr_b16 v[166:167], v237 offset:49664
    v_mfma_f32_32x32x16_bf16 v[148:163], v[176:179], v[56:59], v[148:163]
    ds_read_b64_tr_b16 v[168:169], v237 offset:57344
    ds_read_b64_tr_b16 v[170:171], v237 offset:57856
    s_add_u32 m0, s67, 0xe000
    s_mul_i32 s52, s41, 0x30000
    buffer_load_dwordx4 v241, s[8:11], s52 offen lds
    s_waitcnt lgkmcnt(5)
    v_mfma_f32_32x32x16_bf16 v[132:147], v[212:215], v[60:63], v[132:147]
    s_waitcnt vmcnt(4)
    s_barrier
    v_add_u32 v192, 0xffff0000, v192
    v_add_u32 v193, 0xffff0000, v193
    v_add_u32 v194, 0xffff0000, v194
    v_add_u32 v195, 0xffff0000, v195
    v_add_u32 v2, 0xffff0000, v2
    v_add_u32 v3, 0xffff0000, v3
    v_add_u32 v236, 0xffff0000, v236
    v_add_u32 v237, 0xffff0000, v237
    ds_read_b128 v[68:71], v192 offset:0
    ds_read_b64_tr_b16 v[172:173], v2 offset:16384
    ds_read_b64_tr_b16 v[174:175], v2 offset:16896
    v_mfma_f32_32x32x16_bf16 v[148:163], v[216:219], v[60:63], v[148:163]
    ds_read_b64_tr_b16 v[176:177], v2 offset:24576
    ds_read_b64_tr_b16 v[178:179], v2 offset:25088
    s_add_u32 m0, s66, 0x10000
    s_add_u32 s41, s40, 6
    s_and_b32 s41, s41, 7
    s_mul_i32 s52, s41, 0x80
    buffer_load_dwordx4 v238, s[4:7], s52 offen lds
    s_waitcnt lgkmcnt(5)
    v_mfma_f32_32x32x16_bf16 v[132:147], v[164:167], v[64:67], v[132:147]
    ds_read_b128 v[72:75], v193 offset:0
    ds_read_b64_tr_b16 v[212:213], v3 offset:16384
    ds_read_b64_tr_b16 v[214:215], v3 offset:16896
    v_mfma_f32_32x32x16_bf16 v[148:163], v[168:171], v[64:67], v[148:163]
    ds_read_b64_tr_b16 v[216:217], v3 offset:24576
    ds_read_b64_tr_b16 v[218:219], v3 offset:25088
    s_add_u32 m0, s66, 0x10000
    s_mul_i32 s52, s41, 0x80
    buffer_load_dwordx4 v239, s[4:7], s52 offen offset:1024 lds
    s_waitcnt lgkmcnt(5)
    v_mfma_f32_32x32x16_bf16 v[132:147], v[172:175], v[68:71], v[132:147]
    ds_read_b128 v[76:79], v194 offset:0
    ds_read_b64_tr_b16 v[164:165], v236 offset:16384
    ds_read_b64_tr_b16 v[166:167], v236 offset:16896
    v_mfma_f32_16x16x32_bf16 v[196:199], v[200:203], v[172:175], v[196:199]
    v_mfma_f32_32x32x16_bf16 v[148:163], v[176:179], v[68:71], v[148:163]
    ds_read_b64_tr_b16 v[168:169], v236 offset:24576
    ds_read_b64_tr_b16 v[170:171], v236 offset:25088
    s_add_u32 m0, s67, 0x14000
    s_mul_i32 s52, s41, 0x30000
    buffer_load_dwordx4 v240, s[8:11], s52 offen lds
    v_mfma_f32_16x16x32_bf16 v[188:191], v[200:203], v[176:179], v[188:191]
    s_waitcnt lgkmcnt(5)
    v_mfma_f32_32x32x16_bf16 v[132:147], v[212:215], v[72:75], v[132:147]
    ds_read_b128 v[80:83], v195 offset:0
    ds_read_b64_tr_b16 v[172:173], v237 offset:16384
    ds_read_b64_tr_b16 v[174:175], v237 offset:16896
    v_mfma_f32_32x32x16_bf16 v[148:163], v[216:219], v[72:75], v[148:163]
    ds_read_b64_tr_b16 v[176:177], v237 offset:24576
    ds_read_b64_tr_b16 v[178:179], v237 offset:25088
    s_add_u32 m0, s67, 0x16000
    s_mul_i32 s52, s41, 0x30000
    buffer_load_dwordx4 v241, s[8:11], s52 offen lds
    s_waitcnt lgkmcnt(5)
    v_mfma_f32_32x32x16_bf16 v[132:147], v[164:167], v[76:79], v[132:147]
    s_waitcnt vmcnt(4)
    s_barrier
    ds_read_b128 v[84:87], v192 offset:32768
    ds_read_b64_tr_b16 v[212:213], v2 offset:49152
    ds_read_b64_tr_b16 v[214:215], v2 offset:49664
    v_mfma_f32_32x32x16_bf16 v[148:163], v[168:171], v[76:79], v[148:163]
    ds_read_b64_tr_b16 v[216:217], v2 offset:57344
    ds_read_b64_tr_b16 v[218:219], v2 offset:57856
    s_add_u32 m0, s66, 0x18000
    s_add_u32 s41, s40, 7
    s_and_b32 s41, s41, 7
    s_mul_i32 s52, s41, 0x80
    buffer_load_dwordx4 v238, s[4:7], s52 offen lds
    s_waitcnt lgkmcnt(5)
    v_mfma_f32_32x32x16_bf16 v[132:147], v[172:175], v[80:83], v[132:147]
    ds_read_b128 v[88:91], v193 offset:32768
    ds_read_b64_tr_b16 v[164:165], v3 offset:49152
    ds_read_b64_tr_b16 v[166:167], v3 offset:49664
    v_mfma_f32_32x32x16_bf16 v[148:163], v[176:179], v[80:83], v[148:163]
    ds_read_b64_tr_b16 v[168:169], v3 offset:57344
    ds_read_b64_tr_b16 v[170:171], v3 offset:57856
    s_add_u32 m0, s66, 0x18000
    s_mul_i32 s52, s41, 0x80
    buffer_load_dwordx4 v239, s[4:7], s52 offen offset:1024 lds
    s_lshl_b32 s80, s47, 2
    s_add_u32 s80, s80, s43
    s_lshl_b32 s80, s80, 9
    s_add_u32 s80, s80, 0x1300000
    v_and_b32 v228, 0x1ff, v254
    buffer_load_dwordx4 v[224:227], v228, s[36:39], s80 offen sc1
    s_waitcnt lgkmcnt(5)
    v_mfma_f32_32x32x16_bf16 v[132:147], v[212:215], v[84:87], v[132:147]
    ds_read_b128 v[92:95], v194 offset:32768
    ds_read_b64_tr_b16 v[172:173], v236 offset:49152
    ds_read_b64_tr_b16 v[174:175], v236 offset:49664
    v_mfma_f32_16x16x32_bf16 v[196:199], v[200:203], v[212:215], v[196:199]
    v_mfma_f32_32x32x16_bf16 v[148:163], v[216:219], v[84:87], v[148:163]
    ds_read_b64_tr_b16 v[176:177], v236 offset:57344
    ds_read_b64_tr_b16 v[178:179], v236 offset:57856
    s_add_u32 m0, s67, 0x1c000
    s_mul_i32 s52, s41, 0x30000
    buffer_load_dwordx4 v240, s[8:11], s52 offen lds
    v_mfma_f32_16x16x32_bf16 v[188:191], v[200:203], v[216:219], v[188:191]
    s_waitcnt lgkmcnt(5)
    v_mfma_f32_32x32x16_bf16 v[132:147], v[164:167], v[88:91], v[132:147]
    ds_read_b128 v[96:99], v195 offset:32768
    ds_read_b64_tr_b16 v[212:213], v237 offset:49152
    ds_read_b64_tr_b16 v[214:215], v237 offset:49664
    v_mfma_f32_32x32x16_bf16 v[148:163], v[168:171], v[88:91], v[148:163]
    ds_read_b64_tr_b16 v[216:217], v237 offset:57344
    ds_read_b64_tr_b16 v[218:219], v237 offset:57856
    s_add_u32 m0, s67, 0x1e000
    s_mul_i32 s52, s41, 0x30000
    buffer_load_dwordx4 v241, s[8:11], s52 offen lds
    s_waitcnt lgkmcnt(5)
    v_mfma_f32_32x32x16_bf16 v[132:147], v[172:175], v[92:95], v[132:147]
    s_waitcnt vmcnt(5)
    s_barrier
    v_add_u32 v192, 0x10000, v192
    v_add_u32 v193, 0x10000, v193
    v_add_u32 v194, 0x10000, v194
    v_add_u32 v195, 0x10000, v195
    v_add_u32 v2, 0x10000, v2
    v_add_u32 v3, 0x10000, v3
    v_add_u32 v236, 0x10000, v236
    v_add_u32 v237, 0x10000, v237
    ds_read_b128 v[100:103], v192 offset:0
    ds_read_b64_tr_b16 v[164:165], v2 offset:16384
    ds_read_b64_tr_b16 v[166:167], v2 offset:16896
    v_mfma_f32_32x32x16_bf16 v[148:163], v[176:179], v[92:95], v[148:163]
    ds_read_b64_tr_b16 v[168:169], v2 offset:24576
    ds_read_b64_tr_b16 v[170:171], v2 offset:25088
    s_add_u32 m0, s67, 0x0
    s_add_u32 s41, s40, 0
    s_and_b32 s41, s41, 7
    s_mul_i32 s52, s41, 0x38000
    buffer_load_dwordx4 v242, s[16:19], s52 offen lds
    s_waitcnt lgkmcnt(5)
    v_mfma_f32_32x32x16_bf16 v[132:147], v[212:215], v[96:99], v[132:147]
    ds_read_b128 v[104:107], v193 offset:0
    ds_read_b64_tr_b16 v[172:173], v3 offset:16384
    ds_read_b64_tr_b16 v[174:175], v3 offset:16896
    v_mfma_f32_32x32x16_bf16 v[148:163], v[216:219], v[96:99], v[148:163]
    ds_read_b64_tr_b16 v[176:177], v3 offset:24576
    ds_read_b64_tr_b16 v[178:179], v3 offset:25088
    s_add_u32 m0, s67, 0x2000
    s_add_u32 s41, s40, 1
    s_and_b32 s41, s41, 7
    s_mul_i32 s52, s41, 0x38000
    buffer_load_dwordx4 v242, s[16:19], s52 offen lds
    s_lshl_b32 s54, s47, 2
    s_add_u32 s54, s54, s43
    s_lshl_b32 s55, s48, 2
    s_lshl_b32 s50, s44, 1
    s_add_u32 s55, s55, s50
    s_lshl_b32 s50, s55, 16
    s_lshl_b32 s51, s54, 10
    s_add_u32 s60, s50, s51
    s_add_u32 s61, s60, 65536
    s_mul_i32 s50, s54, 114688
    s_add_u32 s50, s50, 0x800000
    s_lshl_b32 s74, s74, 5
    s_add_u32 s74, s74, s50
    s_lshl_b32 s75, s75, 5
    s_add_u32 s75, s75, s50
    v_and_b32 v220, 0x33, v0
    v_bfe_u32 v221, v0, 2, 1
    v_lshl_add_u32 v220, v221, 3, v220
    v_bfe_u32 v221, v0, 3, 1
    v_lshl_add_u32 v220, v221, 2, v220
    v_lshlrev_b32 v220, 4, v220
    v_add_u32 v238, 0x200000, v220
    s_waitcnt lgkmcnt(5)
    v_mfma_f32_32x32x16_bf16 v[132:147], v[164:167], v[100:103], v[132:147]
    ds_read_b128 v[108:111], v194 offset:0
    ds_read_b64_tr_b16 v[212:213], v236 offset:16384
    ds_read_b64_tr_b16 v[214:215], v236 offset:16896
    v_mfma_f32_16x16x32_bf16 v[196:199], v[200:203], v[164:167], v[196:199]
    v_mfma_f32_32x32x16_bf16 v[148:163], v[168:171], v[100:103], v[148:163]
    ds_read_b64_tr_b16 v[216:217], v236 offset:24576
    ds_read_b64_tr_b16 v[218:219], v236 offset:25088
    s_add_u32 m0, s67, 0x4000
    s_add_u32 s41, s40, 2
    s_and_b32 s41, s41, 7
    s_mul_i32 s52, s41, 0x38000
    buffer_load_dwordx4 v242, s[16:19], s52 offen lds
    v_mfma_f32_16x16x32_bf16 v[188:191], v[200:203], v[168:171], v[188:191]
    s_waitcnt vmcnt(5)
    s_mov_b32 s79, 0x40000
L_rs_6:
    v_cmp_ne_u32 vcc, s78, v225
    v_cmp_ne_u32 s[50:51], s78, v227
    s_nop 0
    s_or_b64 vcc, vcc, s[50:51]
    s_cbranch_vccz L_rsd_7
    buffer_load_dwordx4 v[224:227], v228, s[36:39], s80 offen sc1
    s_sub_u32 s79, s79, 1
    s_cmp_lg_u32 s79, 0
    s_waitcnt vmcnt(0)
    s_cbranch_scc1 L_rs_6
L_rsd_7:
    s_waitcnt lgkmcnt(5)
    v_mfma_f32_32x32x16_bf16 v[132:147], v[172:175], v[104:107], v[132:147]
    ds_read_b128 v[112:115], v195 offset:0
    ds_read_b64_tr_b16 v[164:165], v237 offset:16384
    ds_read_b64_tr_b16 v[166:167], v237 offset:16896
    v_mul_f32 v244, 0xbb000000, v224
    v_mov_b32 v231, 0x3b000000
    v_mul_f32 v230, v244, v244
    v_and_b32 v229, s59, v244
    v_mfma_f32_32x32x16_bf16 v[148:163], v[176:179], v[104:107], v[148:163]
    ds_read_b64_tr_b16 v[168:169], v237 offset:24576
    ds_read_b64_tr_b16 v[170:171], v237 offset:25088
    s_add_u32 m0, s67, 0x6000
    s_add_u32 s41, s40, 3
    s_and_b32 s41, s41, 7
    s_mul_i32 s52, s41, 0x38000
    buffer_load_dwordx4 v242, s[16:19], s52 offen lds
    v_fma_f32 v245, v226, v231, -v230
    v_sub_f32 v229, v244, v229
    v_max_f32 v245, 0, v245
    v_perm_b32 v204, v229, v244, s63
    s_waitcnt lgkmcnt(5)
    v_mfma_f32_32x32x16_bf16 v[132:147], v[212:215], v[108:111], v[132:147]
    s_waitcnt vmcnt(4)
    s_barrier
    ds_read_b128 v[116:119], v192 offset:32768
    ds_read_b64_tr_b16 v[172:173], v2 offset:49152
    ds_read_b64_tr_b16 v[174:175], v2 offset:49664
    v_add_f32 v230, 0x3727c5ac, v245
    v_mov_b32 v205, v204
    v_rcp_f32 v231, v230
    v_rsq_f32 v253, v230
    v_mfma_f32_32x32x16_bf16 v[148:163], v[216:219], v[108:111], v[148:163]
    ds_read_b64_tr_b16 v[176:177], v2 offset:57344
    ds_read_b64_tr_b16 v[178:179], v2 offset:57856
    s_add_u32 m0, s67, 0x8000
    s_add_u32 s41, s40, 4
    s_and_b32 s41, s41, 7
    s_mul_i32 s52, s41, 0x38000
    buffer_load_dwordx4 v242, s[16:19], s52 offen lds
    v_mov_b32 v207, 0
    v_mul_f32 v231, v245, v231
    v_add_f32 v231, 0x3727c5ac, v231
    v_mul_f32 v231, v231, v230
    s_waitcnt lgkmcnt(5)
    v_mfma_f32_32x32x16_bf16 v[132:147], v[164:167], v[112:115], v[132:147]
    ds_read_b128 v[120:123], v193 offset:32768
    ds_read_b64_tr_b16 v[212:213], v3 offset:49152
    ds_read_b64_tr_b16 v[214:215], v3 offset:49664
    v_sqrt_f32 v252, v231
    v_rsq_f32 v250, v231
    v_mul_f32 v231, 0.5, v252
    v_mul_f32 v248, 0xc0135761, v250
    v_mfma_f32_32x32x16_bf16 v[148:163], v[168:171], v[112:115], v[148:163]
    ds_read_b64_tr_b16 v[216:217], v3 offset:57344
    ds_read_b64_tr_b16 v[218:219], v3 offset:57856
    s_add_u32 m0, s67, 0xa000
    s_add_u32 s41, s40, 5
    s_and_b32 s41, s41, 7
    s_mul_i32 s52, s41, 0x38000
    buffer_load_dwordx4 v242, s[16:19], s52 offen lds
    v_and_b32 v230, s59, v231
    v_mul_f32 v250, v250, v250
    v_sub_f32 v230, v231, v230
    v_mul_f32 v250, 0x3d372713, v250
    s_waitcnt lgkmcnt(5)
    v_mfma_f32_32x32x16_bf16 v[132:147], v[172:175], v[116:119], v[132:147]
    ds_read_b128 v[124:127], v194 offset:32768
    ds_read_b64_tr_b16 v[164:165], v236 offset:49152
    ds_read_b64_tr_b16 v[166:167], v236 offset:49664
    v_perm_b32 v206, v230, v231, s63
    v_mul_f32 v250, v248, v250
    v_mul_f32 v234, 0x3eb8aa3b, v253
    v_mfma_f32_16x16x32_bf16 v[196:199], v[200:203], v[172:175], v[196:199]
    v_mfma_f32_32x32x16_bf16 v[148:163], v[176:179], v[116:119], v[148:163]
    ds_read_b64_tr_b16 v[168:169], v236 offset:57344
    ds_read_b64_tr_b16 v[170:171], v236 offset:57856
    s_add_u32 m0, s67, 0xc000
    s_add_u32 s41, s40, 6
    s_and_b32 s41, s41, 7
    s_mul_i32 s52, s41, 0x38000
    buffer_load_dwordx4 v242, s[16:19], s52 offen lds
    v_mfma_f32_16x16x32_bf16 v[188:191], v[200:203], v[176:179], v[188:191]
    s_waitcnt lgkmcnt(5)
    v_mfma_f32_32x32x16_bf16 v[132:147], v[212:215], v[120:123], v[132:147]
    ds_read_b128 v[128:131], v195 offset:32768
    ds_read_b64_tr_b16 v[172:173], v237 offset:49152
    ds_read_b64_tr_b16 v[174:175], v237 offset:49664
    v_mfma_f32_32x32x16_bf16 v[148:163], v[216:219], v[120:123], v[148:163]
    ds_read_b64_tr_b16 v[176:177], v237 offset:57344
    ds_read_b64_tr_b16 v[178:179], v237 offset:57856
    s_add_u32 m0, s67, 0xe000
    s_add_u32 s41, s40, 7
    s_and_b32 s41, s41, 7
    s_mul_i32 s52, s41, 0x38000
    buffer_load_dwordx4 v242, s[16:19], s52 offen lds
    s_lshl_b32 s50, s42, 9
    s_add_u32 s50, s50, 155648
    v_add_u32 v246, s50, v255
    ds_write2st64_b32 v246, v196, v188 offset0:0 offset1:1
    s_lshl_b32 s50, s44, 11
    s_add_u32 s50, s50, 155648
    v_add_u32 v247, s50, v255
    s_waitcnt lgkmcnt(6)
    v_mfma_f32_32x32x16_bf16 v[132:147], v[164:167], v[124:127], v[132:147]
    v_mfma_f32_32x32x16_bf16 v[148:163], v[168:171], v[124:127], v[148:163]
    s_waitcnt lgkmcnt(0)
    s_barrier
    ds_read2st64_b32 v[220:221], v247 offset0:0 offset1:1
    ds_read2st64_b32 v[222:223], v247 offset0:2 offset1:3
    ds_read2st64_b32 v[224:225], v247 offset0:4 offset1:5
    ds_read2st64_b32 v[226:227], v247 offset0:6 offset1:7
    v_mfma_f32_32x32x16_bf16 v[132:147], v[172:175], v[128:131], v[132:147]
    v_mfma_f32_32x32x16_bf16 v[148:163], v[176:179], v[128:131], v[148:163]
    s_waitcnt lgkmcnt(0)
    v_add_f32 v220, v220, v222
    v_add_f32 v224, v224, v226
    v_add_f32 v221, v221, v223
    v_add_f32 v225, v225, v227
    v_add_f32 v246, v220, v224
    v_add_f32 v247, v221, v225
    v_perm_b32 v208, v247, v247, s62
    v_and_b32 v211, s59, v247
    v_sub_f32 v211, v247, v211
    v_perm_b32 v209, v211, v211, s62
    v_mov_b32 v210, 0
    v_mov_b32 v211, 0
    s_nop 1
    v_mfma_f32_32x32x16_bf16 v[148:163], v[208:211], v[204:207], v[148:163]
    v_perm_b32 v208, v246, v246, s62
    v_and_b32 v211, s59, v246
    v_sub_f32 v211, v246, v211
    v_perm_b32 v209, v211, v211, s62
    v_mov_b32 v210, 0
    v_mov_b32 v211, 0
    s_nop 1
    v_mfma_f32_32x32x16_bf16 v[132:147], v[208:211], v[204:207], v[132:147]
    s_nop 2
    v_mul_f32 v148, v148, v253
    v_mul_f32 v149, v149, v253
    v_mul_f32 v150, v150, v253
    v_mul_f32 v151, v151, v253
    v_mul_f32 v152, v152, v253
    v_mul_f32 v153, v153, v253
    v_mul_f32 v154, v154, v253
    v_mul_f32 v155, v155, v253
    v_cvt_pk_bf16_f32 v224, v148, v149
    v_cvt_pk_bf16_f32 v225, v150, v151
    v_cvt_pk_bf16_f32 v226, v152, v153
    v_cvt_pk_bf16_f32 v227, v154, v155
    buffer_store_dwordx4 v[224:227], v238, s[36:39], s60 offen sc1
    v_mul_f32 v156, v156, v253
    v_mul_f32 v157, v157, v253
    v_mul_f32 v158, v158, v253
    v_mul_f32 v159, v159, v253
    v_mul_f32 v160, v160, v253
    v_mul_f32 v161, v161, v253
    v_mul_f32 v162, v162, v253
    v_mul_f32 v163, v163, v253
    v_cvt_pk_bf16_f32 v228, v156, v157
    v_cvt_pk_bf16_f32 v229, v158, v159
    v_cvt_pk_bf16_f32 v230, v160, v161
    v_cvt_pk_bf16_f32 v231, v162, v163
    buffer_store_dwordx4 v[228:231], v238, s[36:39], s61 offen sc1
    v_mul_f32 v132, v132, v234
    v_mul_f32 v133, v133, v234
    v_mul_f32 v134, v134, v234
    v_mul_f32 v135, v135, v234
    v_mul_f32 v136, v136, v234
    v_mul_f32 v137, v137, v234
    v_mul_f32 v138, v138, v234
    v_mul_f32 v139, v139, v234
    v_cvt_pk_bf16_f32 v216, v132, v133
    v_cvt_pk_bf16_f32 v217, v134, v135
    v_cvt_pk_bf16_f32 v218, v136, v137
    v_cvt_pk_bf16_f32 v219, v138, v139
    buffer_store_dwordx4 v[216:219], v254, s[36:39], s60 offen sc1
    v_mul_f32 v140, v140, v234
    v_mul_f32 v141, v141, v234
    v_mul_f32 v142, v142, v234
    v_mul_f32 v143, v143, v234
    v_mul_f32 v144, v144, v234
    v_mul_f32 v145, v145, v234
    v_mul_f32 v146, v146, v234
    v_mul_f32 v147, v147, v234
    v_cvt_pk_bf16_f32 v220, v140, v141
    v_cvt_pk_bf16_f32 v221, v142, v143
    v_cvt_pk_bf16_f32 v222, v144, v145
    v_cvt_pk_bf16_f32 v223, v146, v147
    buffer_store_dwordx4 v[220:223], v254, s[36:39], s61 offen sc1
    s_waitcnt vmcnt(8)
    s_barrier
    v_add_u32 v2, 0xffff0000, v2
    v_add_u32 v3, 0xffff0000, v3
    v_add_u32 v236, 0xffff0000, v236
    v_add_u32 v237, 0xffff0000, v237
    ds_read_b64_tr_b16 v[164:165], v2 offset:0
    ds_read_b64_tr_b16 v[166:167], v2 offset:512
    ds_read_b64_tr_b16 v[172:173], v2 offset:8192
    ds_read_b64_tr_b16 v[174:175], v2 offset:8704
    s_waitcnt lgkmcnt(2)
    v_mfma_f32_32x32x16_bf16 v[180:195], v[164:167], v[4:7], 0
    ds_read_b64_tr_b16 v[168:169], v2 offset:16384
    ds_read_b64_tr_b16 v[170:171], v2 offset:16896
    v_mfma_f32_16x16x32_bf16 v[196:199], v[200:203], v[164:167], 0
    s_waitcnt lgkmcnt(2)
    v_mfma_f32_32x32x16_bf16 v[180:195], v[172:175], v[20:23], v[180:195]
    ds_read_b64_tr_b16 v[176:177], v2 offset:24576
    ds_read_b64_tr_b16 v[178:179], v2 offset:25088
    v_mfma_f32_16x16x32_bf16 v[196:199], v[200:203], v[172:175], v[196:199]
    s_waitcnt lgkmcnt(2)
    v_mfma_f32_32x32x16_bf16 v[180:195], v[168:171], v[36:39], v[180:195]
    ds_read_b64_tr_b16 v[164:165], v3 offset:0
    ds_read_b64_tr_b16 v[166:167], v3 offset:512
    v_mfma_f32_16x16x32_bf16 v[196:199], v[200:203], v[168:171], v[196:199]
    s_waitcnt lgkmcnt(2)
    v_mfma_f32_32x32x16_bf16 v[180:195], v[176:179], v[52:55], v[180:195]
    ds_read_b64_tr_b16 v[172:173], v236 offset:0
    ds_read_b64_tr_b16 v[174:175], v236 offset:512
    v_mfma_f32_16x16x32_bf16 v[196:199], v[200:203], v[176:179], v[196:199]
    s_waitcnt lgkmcnt(2)
    v_mfma_f32_32x32x16_bf16 v[180:195], v[164:167], v[8:11], v[180:195]
    ds_read_b64_tr_b16 v[168:169], v237 offset:0
    ds_read_b64_tr_b16 v[170:171], v237 offset:512
    s_waitcnt lgkmcnt(2)
    v_mfma_f32_32x32x16_bf16 v[180:195], v[172:175], v[12:15], v[180:195]
    ds_read_b64_tr_b16 v[176:177], v3 offset:8192
    ds_read_b64_tr_b16 v[178:179], v3 offset:8704
    s_waitcnt vmcnt(0)
    v_mov_b32 v246, 151552
    v_mov_b32 v247, 1
    s_mov_b64 exec, 1
    ds_add_rtn_u32 v247, v246, v247
    s_mov_b64 exec, -1
    s_waitcnt lgkmcnt(3)
    v_mfma_f32_32x32x16_bf16 v[180:195], v[168:171], v[16:19], v[180:195]
    ds_read_b64_tr_b16 v[164:165], v236 offset:8192
    ds_read_b64_tr_b16 v[166:167], v236 offset:8704
    s_waitcnt lgkmcnt(3)
    v_mfma_f32_32x32x16_bf16 v[180:195], v[176:179], v[24:27], v[180:195]
    ds_read_b64_tr_b16 v[172:173], v237 offset:8192
    ds_read_b64_tr_b16 v[174:175], v237 offset:8704
    s_waitcnt lgkmcnt(4)
    v_readfirstlane_b32 s50, v247
    s_lshl_b32 s51, s48, 12
    s_lshl_b32 s53, s47, 8
    s_add_u32 s51, s51, s53
    s_add_u32 s51, s51, 0x1810000
    s_cmp_lg_u32 s50, 7
    s_cbranch_scc1 L_sig_8
    v_mov_b32 v246, s78
    s_mov_b64 exec, 1
    buffer_store_dword v246, off, s[36:39], s51 sc1
    s_mov_b64 exec, -1
L_sig_8:
    s_waitcnt lgkmcnt(2)
    v_mfma_f32_32x32x16_bf16 v[180:195], v[164:167], v[28:31], v[180:195]
    ds_read_b64_tr_b16 v[168:169], v3 offset:16384
    ds_read_b64_tr_b16 v[170:171], v3 offset:16896
    s_waitcnt lgkmcnt(2)
    v_mfma_f32_32x32x16_bf16 v[180:195], v[172:175], v[32:35], v[180:195]
    ds_read_b64_tr_b16 v[176:177], v236 offset:16384
    ds_read_b64_tr_b16 v[178:179], v236 offset:16896
    s_waitcnt lgkmcnt(2)
    v_mfma_f32_32x32x16_bf16 v[180:195], v[168:171], v[40:43], v[180:195]
    ds_read_b64_tr_b16 v[164:165], v237 offset:16384
    ds_read_b64_tr_b16 v[166:167], v237 offset:16896
    s_waitcnt lgkmcnt(2)
    v_mfma_f32_32x32x16_bf16 v[180:195], v[176:179], v[44:47], v[180:195]
    ds_read_b64_tr_b16 v[172:173], v3 offset:24576
    ds_read_b64_tr_b16 v[174:175], v3 offset:25088
    s_waitcnt lgkmcnt(2)
    v_mfma_f32_32x32x16_bf16 v[180:195], v[164:167], v[48:51], v[180:195]
    ds_read_b64_tr_b16 v[168:169], v236 offset:24576
    ds_read_b64_tr_b16 v[170:171], v236 offset:25088
    s_waitcnt lgkmcnt(2)
    v_mfma_f32_32x32x16_bf16 v[180:195], v[172:175], v[56:59], v[180:195]
    ds_read_b64_tr_b16 v[176:177], v237 offset:24576
    ds_read_b64_tr_b16 v[178:179], v237 offset:25088
    s_barrier
    s_waitcnt lgkmcnt(2)
    v_mfma_f32_32x32x16_bf16 v[180:195], v[168:171], v[60:63], v[180:195]
    ds_read_b64_tr_b16 v[164:165], v2 offset:32768
    ds_read_b64_tr_b16 v[166:167], v2 offset:33280
    s_add_u32 s41, s40, s44
    s_add_u32 s41, s41, 0
    s_and_b32 s41, s41, 7
    s_add_u32 m0, s67, 0x10000
    s_mul_i32 s52, s41, 0x38000
    buffer_load_dwordx4 v243, s[16:19], s52 offen lds
    s_waitcnt lgkmcnt(2)
    v_mfma_f32_32x32x16_bf16 v[180:195], v[176:179], v[64:67], v[180:195]
    ds_read_b64_tr_b16 v[172:173], v2 offset:40960
    ds_read_b64_tr_b16 v[174:175], v2 offset:41472
    s_add_u32 s41, s40, s44
    s_add_u32 s41, s41, 2
    s_and_b32 s41, s41, 7
    s_add_u32 m0, s67, 0x12000
    s_mul_i32 s52, s41, 0x38000
    buffer_load_dwordx4 v243, s[16:19], s52 offen lds
    s_waitcnt lgkmcnt(2)
    v_mfma_f32_32x32x16_bf16 v[180:195], v[164:167], v[68:71], v[180:195]
    ds_read_b64_tr_b16 v[168:169], v2 offset:49152
    ds_read_b64_tr_b16 v[170:171], v2 offset:49664
    v_mfma_f32_16x16x32_bf16 v[196:199], v[200:203], v[164:167], v[196:199]
    s_add_u32 s41, s40, s44
    s_add_u32 s41, s41, 4
    s_and_b32 s41, s41, 7
    s_add_u32 m0, s67, 0x14000
    s_mul_i32 s52, s41, 0x38000
    buffer_load_dwordx4 v243, s[16:19], s52 offen lds
    s_waitcnt lgkmcnt(2)
    v_mfma_f32_32x32x16_bf16 v[180:195], v[172:175], v[84:87], v[180:195]
    ds_read_b64_tr_b16 v[176:177], v2 offset:57344
    ds_read_b64_tr_b16 v[178:179], v2 offset:57856
    v_mfma_f32_16x16x32_bf16 v[196:199], v[200:203], v[172:175], v[196:199]
    s_add_u32 s41, s40, s44
    s_add_u32 s41, s41, 6
    s_and_b32 s41, s41, 7
    s_add_u32 m0, s67, 0x16000
    s_mul_i32 s52, s41, 0x38000
    buffer_load_dwordx4 v243, s[16:19], s52 offen lds
    s_waitcnt lgkmcnt(2)
    v_mfma_f32_32x32x16_bf16 v[180:195], v[168:171], v[100:103], v[180:195]
    ds_read_b64_tr_b16 v[164:165], v3 offset:32768
    ds_read_b64_tr_b16 v[166:167], v3 offset:33280
    v_mfma_f32_16x16x32_bf16 v[196:199], v[200:203], v[168:171], v[196:199]
    v_mov_b32 v132, -1
    v_mov_b32 v133, -1
    v_mov_b32 v134, -1
    v_mov_b32 v135, -1
    s_lshl_b32 s83, s69, 3
    s_add_u32 s83, s83, s42
    s_lshl_b32 s83, s83, 3
    s_add_u32 s83, s83, s45
    s_lshl_b32 s83, s83, 2
    s_lshr_b32 s50, s46, 3
    s_add_u32 s83, s83, s50
    s_lshl_b32 s83, s83, 10
    s_add_u32 s83, s83, 0x600000
    buffer_store_dwordx4 v[132:135], v254, s[36:39], s83 offen sc1
    s_waitcnt lgkmcnt(2)
    v_mfma_f32_32x32x16_bf16 v[180:195], v[176:179], v[116:119], v[180:195]
    ds_read_b64_tr_b16 v[172:173], v236 offset:32768
    ds_read_b64_tr_b16 v[174:175], v236 offset:33280
    v_mfma_f32_16x16x32_bf16 v[196:199], v[200:203], v[176:179], v[196:199]
    s_waitcnt lgkmcnt(2)
    v_mfma_f32_32x32x16_bf16 v[180:195], v[164:167], v[72:75], v[180:195]
    ds_read_b64_tr_b16 v[168:169], v237 offset:32768
    ds_read_b64_tr_b16 v[170:171], v237 offset:33280
    s_waitcnt lgkmcnt(2)
    v_mfma_f32_32x32x16_bf16 v[180:195], v[172:175], v[76:79], v[180:195]
    ds_read_b64_tr_b16 v[176:177], v3 offset:40960
    ds_read_b64_tr_b16 v[178:179], v3 offset:41472
    s_lshl_b32 s50, s42, 8
    s_add_u32 s50, s50, 0x24000
    v_add_u32 v242, s50, v255
    ds_write_b32 v242, v196
    s_lshl_b32 s50, s44, 10
    s_add_u32 s50, s50, 0x24000
    v_add_u32 v242, s50, v255
    s_waitcnt lgkmcnt(3)
    v_mfma_f32_32x32x16_bf16 v[180:195], v[168:171], v[80:83], v[180:195]
    ds_read_b64_tr_b16 v[164:165], v236 offset:40960
    ds_read_b64_tr_b16 v[166:167], v236 offset:41472
    s_lshl_b32 s81, s45, 12
    s_add_u32 s81, s81, 0x1810000
    s_cmp_lg_u32 s42, 4
    s_cbranch_scc1 L_li_9
    v_and_b32 v241, 31, v0
    v_lshlrev_b32 v241, 7, v241
    buffer_load_dword v240, v241, s[36:39], s81 offen sc1
L_li_9:
    s_waitcnt lgkmcnt(3)
    v_mfma_f32_32x32x16_bf16 v[180:195], v[176:179], v[88:91], v[180:195]
    ds_read_b64_tr_b16 v[172:173], v237 offset:40960
    ds_read_b64_tr_b16 v[174:175], v237 offset:41472
    s_waitcnt lgkmcnt(4)
    s_barrier
    ds_read2st64_b32 v[196:197], v242 offset0:0 offset1:1
    ds_read2st64_b32 v[198:199], v242 offset0:2 offset1:3
    s_waitcnt lgkmcnt(4)
    v_mfma_f32_32x32x16_bf16 v[180:195], v[164:167], v[92:95], v[180:195]
    ds_read_b64_tr_b16 v[168:169], v3 offset:49152
    ds_read_b64_tr_b16 v[170:171], v3 offset:49664
    s_waitcnt lgkmcnt(4)
    v_mfma_f32_32x32x16_bf16 v[180:195], v[172:175], v[96:99], v[180:195]
    ds_read_b64_tr_b16 v[176:177], v236 offset:49152
    ds_read_b64_tr_b16 v[178:179], v236 offset:49664
    s_waitcnt lgkmcnt(2)
    v_mfma_f32_32x32x16_bf16 v[180:195], v[168:171], v[104:107], v[180:195]
    ds_read_b64_tr_b16 v[164:165], v237 offset:49152
    ds_read_b64_tr_b16 v[166:167], v237 offset:49664
    v_add_f32 v196, v196, v197
    v_add_f32 v198, v198, v199
    v_add_f32 v196, v196, v198
    v_perm_b32 v208, v196, v196, s62
    v_and_b32 v211, s59, v196
    v_sub_f32 v211, v196, v211
    v_perm_b32 v209, v211, v211, s62
    v_perm_b32 v210, v249, v249, s64
    v_mov_b32 v211, 0
    s_waitcnt lgkmcnt(2)
    v_mfma_f32_32x32x16_bf16 v[180:195], v[176:179], v[108:111], v[180:195]
    ds_read_b64_tr_b16 v[172:173], v3 offset:57344
    ds_read_b64_tr_b16 v[174:175], v3 offset:57856
    v_mfma_f32_32x32x16_bf16 v[180:195], v[208:211], v[204:207], v[180:195]
    s_waitcnt lgkmcnt(2)
    v_mfma_f32_32x32x16_bf16 v[180:195], v[164:167], v[112:115], v[180:195]
    ds_read_b64_tr_b16 v[168:169], v236 offset:57344
    ds_read_b64_tr_b16 v[170:171], v236 offset:57856
    s_waitcnt lgkmcnt(2)
    v_mfma_f32_32x32x16_bf16 v[180:195], v[172:175], v[120:123], v[180:195]
    ds_read_b64_tr_b16 v[176:177], v237 offset:57344
    ds_read_b64_tr_b16 v[178:179], v237 offset:57856
    s_waitcnt lgkmcnt(2)
    v_mfma_f32_32x32x16_bf16 v[180:195], v[168:171], v[124:127], v[180:195]
    s_waitcnt lgkmcnt(0)
    v_mfma_f32_32x32x16_bf16 v[180:195], v[176:179], v[128:131], v[180:195]
    s_waitcnt vmcnt(1)
    s_cmp_lg_u32 s42, 4
    s_cbranch_scc1 L_np1b_10
    s_waitcnt vmcnt(0)
    v_cmp_ne_u32 vcc, s78, v240
    v_mov_b32 v246, 151556
    s_cmp_eq_u64 vcc, 0
    s_cselect_b32 s50, 1, 0
    v_mov_b32 v247, s50
    ds_write_b32 v246, v247
    s_cbranch_scc1 L_np1b_10
    buffer_load_dword v240, v241, s[36:39], s81 offen sc1
L_np1b_10:
    s_mov_b32 s56, 0
    v_mov_b32 v239, 151556
    s_waitcnt lgkmcnt(0)
    s_barrier
    ds_read_b32 v239, v239
    s_cmp_lg_u32 s44, 0
    s_cbranch_scc1 L_slot1_11
    v_lshrrev_b32 v213, 5, v0
    v_bfe_u32 v214, v0, 2, 2
    v_lshl_add_u32 v214, v213, 3, v214
    v_lshlrev_b32 v214, 6, v214
    v_bfe_u32 v215, v0, 4, 1
    v_lshl_add_u32 v214, v215, 5, v214
    v_and_b32 v215, 3, v0
    v_lshl_add_u32 v214, v215, 3, v214
    s_lshl_b32 s50, s49, 10
    s_add_u32 s50, s50, 65536
    v_add_u32 v2, s50, v214
    v_xor_b32 v3, 1024, v2
    v_xor_b32 v236, 2048, v2
    v_xor_b32 v237, 3072, v2
    ds_read_b64_tr_b16 v[164:165], v2 offset:0
    ds_read_b64_tr_b16 v[166:167], v2 offset:256
    ds_read_b64_tr_b16 v[172:173], v2 offset:4096
    ds_read_b64_tr_b16 v[174:175], v2 offset:4352
    s_waitcnt lgkmcnt(2)
    v_mfma_f32_32x32x16_bf16 v[132:147], v[164:167], v[4:7], 0
    ds_read_b64_tr_b16 v[168:169], v2 offset:8192
    ds_read_b64_tr_b16 v[170:171], v2 offset:8448
    v_mfma_f32_16x16x32_bf16 v[196:199], v[200:203], v[164:167], 0
    s_waitcnt lgkmcnt(2)
    v_mfma_f32_32x32x16_bf16 v[132:147], v[172:175], v[20:23], v[132:147]
    ds_read_b64_tr_b16 v[176:177], v2 offset:12288
    ds_read_b64_tr_b16 v[178:179], v2 offset:12544
    v_mfma_f32_16x16x32_bf16 v[196:199], v[200:203], v[172:175], v[196:199]
    s_waitcnt lgkmcnt(2)
    v_mfma_f32_32x32x16_bf16 v[132:147], v[168:171], v[36:39], v[132:147]
    ds_read_b64_tr_b16 v[164:165], v2 offset:16384
    ds_read_b64_tr_b16 v[166:167], v2 offset:16640
    v_mfma_f32_16x16x32_bf16 v[196:199], v[200:203], v[168:171], v[196:199]
    s_waitcnt lgkmcnt(2)
    v_mfma_f32_32x32x16_bf16 v[132:147], v[176:179], v[52:55], v[132:147]
    ds_read_b64_tr_b16 v[172:173], v2 offset:20480
    ds_read_b64_tr_b16 v[174:175], v2 offset:20736
    v_mfma_f32_16x16x32_bf16 v[196:199], v[200:203], v[176:179], v[196:199]
    s_waitcnt lgkmcnt(2)
    v_mfma_f32_32x32x16_bf16 v[132:147], v[164:167], v[68:71], v[132:147]
    ds_read_b64_tr_b16 v[168:169], v2 offset:24576
    ds_read_b64_tr_b16 v[170:171], v2 offset:24832
    v_mfma_f32_16x16x32_bf16 v[196:199], v[200:203], v[164:167], v[196:199]
    s_waitcnt lgkmcnt(2)
    v_mfma_f32_32x32x16_bf16 v[132:147], v[172:175], v[84:87], v[132:147]
    ds_read_b64_tr_b16 v[176:177], v2 offset:28672
    ds_read_b64_tr_b16 v[178:179], v2 offset:28928
    v_mfma_f32_16x16x32_bf16 v[196:199], v[200:203], v[172:175], v[196:199]
    s_waitcnt lgkmcnt(2)
    v_mfma_f32_32x32x16_bf16 v[132:147], v[168:171], v[100:103], v[132:147]
    ds_read_b64_tr_b16 v[164:165], v3 offset:0
    ds_read_b64_tr_b16 v[166:167], v3 offset:256
    v_mfma_f32_16x16x32_bf16 v[196:199], v[200:203], v[168:171], v[196:199]
    s_waitcnt lgkmcnt(2)
    v_mfma_f32_32x32x16_bf16 v[132:147], v[176:179], v[116:119], v[132:147]
    ds_read_b64_tr_b16 v[172:173], v236 offset:0
    ds_read_b64_tr_b16 v[174:175], v236 offset:256
    v_mfma_f32_16x16x32_bf16 v[196:199], v[200:203], v[176:179], v[196:199]
    s_waitcnt lgkmcnt(2)
    v_mfma_f32_32x32x16_bf16 v[132:147], v[164:167], v[8:11], v[132:147]
    ds_read_b64_tr_b16 v[168:169], v237 offset:0
    ds_read_b64_tr_b16 v[170:171], v237 offset:256
    s_waitcnt lgkmcnt(2)
    v_mfma_f32_32x32x16_bf16 v[132:147], v[172:175], v[12:15], v[132:147]
    ds_read_b64_tr_b16 v[176:177], v3 offset:4096
    ds_read_b64_tr_b16 v[178:179], v3 offset:4352
    s_lshl_b32 s50, s42, 8
    s_add_u32 s50, s50, 0x24800
    v_add_u32 v242, s50, v255
    ds_write_b32 v242, v196
    s_lshl_b32 s50, s44, 10
    s_add_u32 s50, s50, 0x24800
    v_add_u32 v242, s50, v255
    s_waitcnt lgkmcnt(3)
    v_mfma_f32_32x32x16_bf16 v[132:147], v[168:171], v[16:19], v[132:147]
    ds_read_b64_tr_b16 v[164:165], v236 offset:4096
    ds_read_b64_tr_b16 v[166:167], v236 offset:4352
    s_waitcnt lgkmcnt(3)
    v_mfma_f32_32x32x16_bf16 v[132:147], v[176:179], v[24:27], v[132:147]
    ds_read_b64_tr_b16 v[172:173], v237 offset:4096
    ds_read_b64_tr_b16 v[174:175], v237 offset:4352
    s_waitcnt lgkmcnt(4)
    s_barrier
    ds_read2st64_b32 v[196:197], v242 offset0:0 offset1:1
    ds_read2st64_b32 v[198:199], v242 offset0:2 offset1:3
    s_waitcnt lgkmcnt(4)
    v_mfma_f32_32x32x16_bf16 v[132:147], v[164:167], v[28:31], v[132:147]
    ds_read_b64_tr_b16 v[168:169], v3 offset:8192
    ds_read_b64_tr_b16 v[170:171], v3 offset:8448
    s_waitcnt lgkmcnt(4)
    v_mfma_f32_32x32x16_bf16 v[132:147], v[172:175], v[32:35], v[132:147]
    ds_read_b64_tr_b16 v[176:177], v236 offset:8192
    ds_read_b64_tr_b16 v[178:179], v236 offset:8448
    s_waitcnt lgkmcnt(2)
    v_mfma_f32_32x32x16_bf16 v[132:147], v[168:171], v[40:43], v[132:147]
    ds_read_b64_tr_b16 v[164:165], v237 offset:8192
    ds_read_b64_tr_b16 v[166:167], v237 offset:8448
    v_add_f32 v196, v196, v197
    v_add_f32 v198, v198, v199
    v_add_f32 v196, v196, v198
    v_perm_b32 v208, v196, v196, s62
    v_and_b32 v211, s59, v196
    v_sub_f32 v211, v196, v211
    v_perm_b32 v209, v211, v211, s62
    v_perm_b32 v210, v251, v251, s64
    v_mov_b32 v211, 0
    s_waitcnt lgkmcnt(2)
    v_mfma_f32_32x32x16_bf16 v[132:147], v[176:179], v[44:47], v[132:147]
    ds_read_b64_tr_b16 v[172:173], v3 offset:12288
    ds_read_b64_tr_b16 v[174:175], v3 offset:12544
    v_mfma_f32_32x32x16_bf16 v[132:147], v[208:211], v[204:207], v[132:147]
    s_waitcnt lgkmcnt(2)
    v_mfma_f32_32x32x16_bf16 v[132:147], v[164:167], v[48:51], v[132:147]
    ds_read_b64_tr_b16 v[168:169], v236 offset:12288
    ds_read_b64_tr_b16 v[170:171], v236 offset:12544
    s_waitcnt lgkmcnt(2)
    v_mfma_f32_32x32x16_bf16 v[132:147], v[172:175], v[56:59], v[132:147]
    ds_read_b64_tr_b16 v[176:177], v237 offset:12288
    ds_read_b64_tr_b16 v[178:179], v237 offset:12544
    s_waitcnt lgkmcnt(2)
    v_mfma_f32_32x32x16_bf16 v[132:147], v[168:171], v[60:63], v[132:147]
    ds_read_b64_tr_b16 v[164:165], v3 offset:16384
    ds_read_b64_tr_b16 v[166:167], v3 offset:16640
    s_waitcnt lgkmcnt(2)
    v_mfma_f32_32x32x16_bf16 v[132:147], v[176:179], v[64:67], v[132:147]
    ds_read_b64_tr_b16 v[172:173], v236 offset:16384
    ds_read_b64_tr_b16 v[174:175], v236 offset:16640
    s_waitcnt lgkmcnt(2)
    v_mfma_f32_32x32x16_bf16 v[132:147], v[164:167], v[72:75], v[132:147]
    ds_read_b64_tr_b16 v[168:169], v237 offset:16384
    ds_read_b64_tr_b16 v[170:171], v237 offset:16640
    s_waitcnt lgkmcnt(2)
    v_mfma_f32_32x32x16_bf16 v[132:147], v[172:175], v[76:79], v[132:147]
    ds_read_b64_tr_b16 v[176:177], v3 offset:20480
    ds_read_b64_tr_b16 v[178:179], v3 offset:20736
    s_waitcnt lgkmcnt(2)
    v_mfma_f32_32x32x16_bf16 v[132:147], v[168:171], v[80:83], v[132:147]
    ds_read_b64_tr_b16 v[164:165], v236 offset:20480
    ds_read_b64_tr_b16 v[166:167], v236 offset:20736
    s_waitcnt lgkmcnt(2)
    v_mfma_f32_32x32x16_bf16 v[132:147], v[176:179], v[88:91], v[132:147]
    ds_read_b64_tr_b16 v[172:173], v237 offset:20480
    ds_read_b64_tr_b16 v[174:175], v237 offset:20736
    s_waitcnt lgkmcnt(2)
    v_mfma_f32_32x32x16_bf16 v[132:147], v[164:167], v[92:95], v[132:147]
    ds_read_b64_tr_b16 v[168:169], v3 offset:24576
    ds_read_b64_tr_b16 v[170:171], v3 offset:24832
    s_waitcnt lgkmcnt(2)
    v_mfma_f32_32x32x16_bf16 v[132:147], v[172:175], v[96:99], v[132:147]
    ds_read_b64_tr_b16 v[176:177], v236 offset:24576
    ds_read_b64_tr_b16 v[178:179], v236 offset:24832
    s_waitcnt lgkmcnt(2)
    v_mfma_f32_32x32x16_bf16 v[132:147], v[168:171], v[104:107], v[132:147]
    ds_read_b64_tr_b16 v[164:165], v237 offset:24576
    ds_read_b64_tr_b16 v[166:167], v237 offset:24832
    s_waitcnt lgkmcnt(2)
    v_mfma_f32_32x32x16_bf16 v[132:147], v[176:179], v[108:111], v[132:147]
    ds_read_b64_tr_b16 v[172:173], v3 offset:28672
    ds_read_b64_tr_b16 v[174:175], v3 offset:28928
    s_waitcnt lgkmcnt(2)
    v_mfma_f32_32x32x16_bf16 v[132:147], v[164:167], v[112:115], v[132:147]
    ds_read_b64_tr_b16 v[168:169], v236 offset:28672
    ds_read_b64_tr_b16 v[170:171], v236 offset:28928
    s_waitcnt lgkmcnt(2)
    v_mfma_f32_32x32x16_bf16 v[132:147], v[172:175], v[120:123], v[132:147]
    ds_read_b64_tr_b16 v[176:177], v237 offset:28672
    ds_read_b64_tr_b16 v[178:179], v237 offset:28928
    s_waitcnt lgkmcnt(2)
    v_mfma_f32_32x32x16_bf16 v[132:147], v[168:171], v[124:127], v[132:147]
    s_waitcnt lgkmcnt(0)
    v_mfma_f32_32x32x16_bf16 v[132:147], v[176:179], v[128:131], v[132:147]
    s_lshl_b32 s50, s43, 12
    s_add_u32 s50, s50, 131072
    v_add_u32 v246, s50, v254
    s_nop 8
    ds_write_b128 v246, v[132:135] offset:0
    ds_write_b128 v246, v[136:139] offset:1024
    ds_write_b128 v246, v[140:143] offset:2048
    ds_write_b128 v246, v[144:147] offset:3072
    s_waitcnt lgkmcnt(0)
    s_barrier
    v_pk_mul_f32 v[216:217], v[180:181], v[180:181]
    v_pk_mul_f32 v[218:219], v[182:183], v[182:183]
    v_pk_mul_f32 v[220:221], v[184:185], v[184:185]
    v_pk_mul_f32 v[222:223], v[186:187], v[186:187]
    v_pk_fma_f32 v[216:217], v[216:217], v[250:251], v[248:249] op_sel_hi:[1,0,0]
    v_pk_fma_f32 v[218:219], v[218:219], v[250:251], v[248:249] op_sel_hi:[1,0,0]
    v_pk_fma_f32 v[220:221], v[220:221], v[250:251], v[248:249] op_sel_hi:[1,0,0]
    v_pk_fma_f32 v[222:223], v[222:223], v[250:251], v[248:249] op_sel_hi:[1,0,0]
    v_pk_mul_f32 v[216:217], v[216:217], v[180:181]
    v_pk_mul_f32 v[218:219], v[218:219], v[182:183]
    v_pk_mul_f32 v[220:221], v[220:221], v[184:185]
    v_pk_mul_f32 v[222:223], v[222:223], v[186:187]
    v_exp_f32 v216, v216
    v_exp_f32 v217, v217
    v_exp_f32 v218, v218
    v_exp_f32 v219, v219
    v_exp_f32 v220, v220
    v_exp_f32 v221, v221
    v_exp_f32 v222, v222
    v_exp_f32 v223, v223
    v_pk_fma_f32 v[216:217], v[216:217], v[252:253], v[252:253] op_sel_hi:[1,0,0]
    v_pk_fma_f32 v[218:219], v[218:219], v[252:253], v[252:253] op_sel_hi:[1,0,0]
    v_pk_fma_f32 v[220:221], v[220:221], v[252:253], v[252:253] op_sel_hi:[1,0,0]
    v_pk_fma_f32 v[222:223], v[222:223], v[252:253], v[252:253] op_sel_hi:[1,0,0]
    v_rcp_f32 v216, v216
    v_rcp_f32 v217, v217
    v_rcp_f32 v218, v218
    v_rcp_f32 v219, v219
    v_rcp_f32 v220, v220
    v_rcp_f32 v221, v221
    v_rcp_f32 v222, v222
    v_rcp_f32 v223, v223
    v_pk_mul_f32 v[216:217], v[216:217], v[180:181]
    v_pk_mul_f32 v[218:219], v[218:219], v[182:183]
    v_pk_mul_f32 v[220:221], v[220:221], v[184:185]
    v_pk_mul_f32 v[222:223], v[222:223], v[186:187]
    v_cvt_pk_bf16_f32 v180, v216, v217
    v_cvt_pk_bf16_f32 v181, v218, v219
    v_cvt_pk_bf16_f32 v182, v220, v221
    v_cvt_pk_bf16_f32 v183, v222, v223
    buffer_store_dwordx4 v[180:183], v254, s[36:39], s74 offen offset:0 sc1
    v_pk_mul_f32 v[224:225], v[188:189], v[188:189]
    v_pk_mul_f32 v[226:227], v[190:191], v[190:191]
    v_pk_mul_f32 v[228:229], v[192:193], v[192:193]
    v_pk_mul_f32 v[230:231], v[194:195], v[194:195]
    v_pk_fma_f32 v[224:225], v[224:225], v[250:251], v[248:249] op_sel_hi:[1,0,0]
    v_pk_fma_f32 v[226:227], v[226:227], v[250:251], v[248:249] op_sel_hi:[1,0,0]
    v_pk_fma_f32 v[228:229], v[228:229], v[250:251], v[248:249] op_sel_hi:[1,0,0]
    v_pk_fma_f32 v[230:231], v[230:231], v[250:251], v[248:249] op_sel_hi:[1,0,0]
    v_pk_mul_f32 v[224:225], v[224:225], v[188:189]
    v_pk_mul_f32 v[226:227], v[226:227], v[190:191]
    v_pk_mul_f32 v[228:229], v[228:229], v[192:193]
    v_pk_mul_f32 v[230:231], v[230:231], v[194:195]
    v_exp_f32 v224, v224
    v_exp_f32 v225, v225
    v_exp_f32 v226, v226
    v_exp_f32 v227, v227
    v_exp_f32 v228, v228
    v_exp_f32 v229, v229
    v_exp_f32 v230, v230
    v_exp_f32 v231, v231
    v_pk_fma_f32 v[224:225], v[224:225], v[252:253], v[252:253] op_sel_hi:[1,0,0]
    v_pk_fma_f32 v[226:227], v[226:227], v[252:253], v[252:253] op_sel_hi:[1,0,0]
    v_pk_fma_f32 v[228:229], v[228:229], v[252:253], v[252:253] op_sel_hi:[1,0,0]
    v_pk_fma_f32 v[230:231], v[230:231], v[252:253], v[252:253] op_sel_hi:[1,0,0]
    v_rcp_f32 v224, v224
    v_rcp_f32 v225, v225
    v_rcp_f32 v226, v226
    v_rcp_f32 v227, v227
    v_rcp_f32 v228, v228
    v_rcp_f32 v229, v229
    v_rcp_f32 v230, v230
    v_rcp_f32 v231, v231
    v_pk_mul_f32 v[224:225], v[224:225], v[188:189]
    v_pk_mul_f32 v[226:227], v[226:227], v[190:191]
    v_pk_mul_f32 v[228:229], v[228:229], v[192:193]
    v_pk_mul_f32 v[230:231], v[230:231], v[194:195]
    v_cvt_pk_bf16_f32 v188, v224, v225
    v_cvt_pk_bf16_f32 v189, v226, v227
    v_cvt_pk_bf16_f32 v190, v228, v229
    v_cvt_pk_bf16_f32 v191, v230, v231
    buffer_store_dwordx4 v[188:191], v254, s[36:39], s74 offen offset:1024 sc1
    s_branch L_p1join_12
L_slot1_11:
    s_waitcnt lgkmcnt(0)
    s_cmp_lg_u32 s56, 0
    s_cbranch_scc1 L_te_13
    v_readfirstlane_b32 s50, v239
    s_nop 0
    s_cmp_eq_u32 s50, 0
    s_cbranch_scc1 L_te_13
    s_mov_b32 s56, 1
    s_lshl_b32 s51, s43, 11
    s_lshl_b32 s80, s68, 16
    s_add_u32 s80, s80, s51
    s_add_u32 m0, s51, 0
    s_add_u32 s52, s80, 0x200000
    buffer_load_dwordx4 v254, s[36:39], s52 offen sc1 lds
    buffer_load_dwordx4 v254, s[36:39], s52 offen offset:1024 sc1 lds
    s_add_u32 m0, s51, 155648
    s_lshl_b32 s52, s69, 13
    s_add_u32 s52, s52, s80
    buffer_load_dwordx4 v254, s[36:39], s52 offen sc1 lds
    buffer_load_dwordx4 v254, s[36:39], s52 offen offset:1024 sc1 lds
    s_add_u32 m0, s51, 98304
    s_add_u32 s52, s80, 0x400000
    buffer_load_dwordx4 v254, s[36:39], s52 offen sc1 lds
    buffer_load_dwordx4 v254, s[36:39], s52 offen offset:1024 sc1 lds
    s_add_u32 m0, s51, 8192
    s_add_u32 s52, s80, 0x202000
    buffer_load_dwordx4 v254, s[36:39], s52 offen sc1 lds
    buffer_load_dwordx4 v254, s[36:39], s52 offen offset:1024 sc1 lds
    s_add_u32 m0, s51, 106496
    s_add_u32 s52, s80, 0x402000
    buffer_load_dwordx4 v254, s[36:39], s52 offen sc1 lds
    buffer_load_dwordx4 v254, s[36:39], s52 offen offset:1024 sc1 lds
L_te_13:
    v_mul_f32 v216, v180, v180
    v_mul_f32 v217, v181, v181
    v_mul_f32 v218, v182, v182
    v_mul_f32 v219, v183, v183
    v_mul_f32 v220, v184, v184
    v_mul_f32 v221, v185, v185
    v_mul_f32 v222, v186, v186
    v_mul_f32 v223, v187, v187
    v_fma_f32 v216, v216, v250, v248
    v_fma_f32 v217, v217, v250, v248
    v_fma_f32 v218, v218, v250, v248
    v_fma_f32 v219, v219, v250, v248
    v_fma_f32 v220, v220, v250, v248
    v_fma_f32 v221, v221, v250, v248
    v_fma_f32 v222, v222, v250, v248
    v_fma_f32 v223, v223, v250, v248
    v_mul_f32 v216, v216, v180
    v_mul_f32 v217, v217, v181
    v_mul_f32 v218, v218, v182
    v_mul_f32 v219, v219, v183
    v_mul_f32 v220, v220, v184
    v_mul_f32 v221, v221, v185
    v_mul_f32 v222, v222, v186
    v_mul_f32 v223, v223, v187
    s_barrier
    v_exp_f32 v216, v216
    v_exp_f32 v217, v217
    v_exp_f32 v218, v218
    v_exp_f32 v219, v219
    v_exp_f32 v220, v220
    v_exp_f32 v221, v221
    v_exp_f32 v222, v222
    v_exp_f32 v223, v223
    v_fma_f32 v216, v216, v252, v252
    v_fma_f32 v217, v217, v252, v252
    v_fma_f32 v218, v218, v252, v252
    v_fma_f32 v219, v219, v252, v252
    v_fma_f32 v220, v220, v252, v252
    v_fma_f32 v221, v221, v252, v252
    v_fma_f32 v222, v222, v252, v252
    v_fma_f32 v223, v223, v252, v252
    v_rcp_f32 v216, v216
    v_rcp_f32 v217, v217
    v_rcp_f32 v218, v218
    v_rcp_f32 v219, v219
    v_rcp_f32 v220, v220
    v_rcp_f32 v221, v221
    v_rcp_f32 v222, v222
    v_rcp_f32 v223, v223
    v_mul_f32 v216, v216, v180
    v_mul_f32 v217, v217, v181
    v_mul_f32 v218, v218, v182
    v_mul_f32 v219, v219, v183
    v_mul_f32 v220, v220, v184
    v_mul_f32 v221, v221, v185
    v_mul_f32 v222, v222, v186
    v_mul_f32 v223, v223, v187
    v_cvt_pk_bf16_f32 v180, v216, v217
    v_cvt_pk_bf16_f32 v181, v218, v219
    v_cvt_pk_bf16_f32 v182, v220, v221
    v_cvt_pk_bf16_f32 v183, v222, v223
    s_cmp_lg_u32 s56, 0
    s_cbranch_scc1 L_lw_15
    s_cmp_lg_u32 s42, 4
    s_cbranch_scc1 L_lw_15
    s_mov_b32 s79, 0x40000
L_poll_16:
    s_waitcnt vmcnt(0)
    v_cmp_ne_u32 vcc, s78, v240
    s_nop 0
    s_cbranch_vccz L_polld_17
    buffer_load_dword v240, v241, s[36:39], s81 offen sc1
    s_sub_u32 s79, s79, 1
    s_cmp_lg_u32 s79, 0
    s_cbranch_scc1 L_poll_16
    s_waitcnt vmcnt(0)
L_polld_17:
    v_mov_b32 v240, 151556
    v_mov_b32 v241, 1
    ds_write_b32 v240, v241
    s_mov_b32 s56, 1
    s_lshl_b32 s51, s43, 11
    s_lshl_b32 s80, s68, 16
    s_add_u32 s80, s80, s51
    s_add_u32 m0, s51, 0
    s_add_u32 s52, s80, 0x200000
    buffer_load_dwordx4 v254, s[36:39], s52 offen sc1 lds
    buffer_load_dwordx4 v254, s[36:39], s52 offen offset:1024 sc1 lds
    s_add_u32 m0, s51, 155648
    s_lshl_b32 s52, s69, 13
    s_add_u32 s52, s52, s80
    buffer_load_dwordx4 v254, s[36:39], s52 offen sc1 lds
    buffer_load_dwordx4 v254, s[36:39], s52 offen offset:1024 sc1 lds
    s_add_u32 m0, s51, 98304
    s_add_u32 s52, s80, 0x400000
    buffer_load_dwordx4 v254, s[36:39], s52 offen sc1 lds
    buffer_load_dwordx4 v254, s[36:39], s52 offen offset:1024 sc1 lds
    s_add_u32 m0, s51, 8192
    s_add_u32 s52, s80, 0x202000
    buffer_load_dwordx4 v254, s[36:39], s52 offen sc1 lds
    buffer_load_dwordx4 v254, s[36:39], s52 offen offset:1024 sc1 lds
    s_add_u32 m0, s51, 106496
    s_add_u32 s52, s80, 0x402000
    buffer_load_dwordx4 v254, s[36:39], s52 offen sc1 lds
    buffer_load_dwordx4 v254, s[36:39], s52 offen offset:1024 sc1 lds
L_lw_15:
    s_cmp_lg_u32 s56, 0
    s_cbranch_scc1 L_te_18
    s_mov_b32 s79, 0x800000
L_ts_19:
    v_mov_b32 v239, 151556
    ds_read_b32 v239, v239
    s_sub_u32 s79, s79, 1
    s_waitcnt lgkmcnt(0)
    v_readfirstlane_b32 s50, v239
    s_cmp_eq_u32 s79, 0
    s_cselect_b32 s50, 1, s50
    s_cmp_eq_u32 s50, 0
    s_cbranch_scc1 L_ts_19
    s_mov_b32 s56, 1
    s_lshl_b32 s51, s43, 11
    s_lshl_b32 s80, s68, 16
    s_add_u32 s80, s80, s51
    s_add_u32 m0, s51, 0
    s_add_u32 s52, s80, 0x200000
    buffer_load_dwordx4 v254, s[36:39], s52 offen sc1 lds
    buffer_load_dwordx4 v254, s[36:39], s52 offen offset:1024 sc1 lds
    s_add_u32 m0, s51, 155648
    s_lshl_b32 s52, s69, 13
    s_add_u32 s52, s52, s80
    buffer_load_dwordx4 v254, s[36:39], s52 offen sc1 lds
    buffer_load_dwordx4 v254, s[36:39], s52 offen offset:1024 sc1 lds
    s_add_u32 m0, s51, 98304
    s_add_u32 s52, s80, 0x400000
    buffer_load_dwordx4 v254, s[36:39], s52 offen sc1 lds
    buffer_load_dwordx4 v254, s[36:39], s52 offen offset:1024 sc1 lds
    s_add_u32 m0, s51, 8192
    s_add_u32 s52, s80, 0x202000
    buffer_load_dwordx4 v254, s[36:39], s52 offen sc1 lds
    buffer_load_dwordx4 v254, s[36:39], s52 offen offset:1024 sc1 lds
    s_add_u32 m0, s51, 106496
    s_add_u32 s52, s80, 0x402000
    buffer_load_dwordx4 v254, s[36:39], s52 offen sc1 lds
    buffer_load_dwordx4 v254, s[36:39], s52 offen offset:1024 sc1 lds
L_te_18:
    buffer_store_dwordx4 v[180:183], v254, s[36:39], s74 offen offset:0 sc1
    v_mul_f32 v224, v188, v188
    v_mul_f32 v225, v189, v189
    v_mul_f32 v226, v190, v190
    v_mul_f32 v227, v191, v191
    v_mul_f32 v228, v192, v192
    v_mul_f32 v229, v193, v193
    v_mul_f32 v230, v194, v194
    v_mul_f32 v231, v195, v195
    v_fma_f32 v224, v224, v250, v248
    v_fma_f32 v225, v225, v250, v248
    v_fma_f32 v226, v226, v250, v248
    v_fma_f32 v227, v227, v250, v248
    v_fma_f32 v228, v228, v250, v248
    v_fma_f32 v229, v229, v250, v248
    v_fma_f32 v230, v230, v250, v248
    v_fma_f32 v231, v231, v250, v248
    v_mul_f32 v224, v224, v188
    v_mul_f32 v225, v225, v189
    v_mul_f32 v226, v226, v190
    v_mul_f32 v227, v227, v191
    v_mul_f32 v228, v228, v192
    v_mul_f32 v229, v229, v193
    v_mul_f32 v230, v230, v194
    v_mul_f32 v231, v231, v195
    v_exp_f32 v224, v224
    v_exp_f32 v225, v225
    v_exp_f32 v226, v226
    v_exp_f32 v227, v227
    v_exp_f32 v228, v228
    v_exp_f32 v229, v229
    v_exp_f32 v230, v230
    v_exp_f32 v231, v231
    v_fma_f32 v224, v224, v252, v252
    v_fma_f32 v225, v225, v252, v252
    v_fma_f32 v226, v226, v252, v252
    v_fma_f32 v227, v227, v252, v252
    v_fma_f32 v228, v228, v252, v252
    v_fma_f32 v229, v229, v252, v252
    v_fma_f32 v230, v230, v252, v252
    v_fma_f32 v231, v231, v252, v252
    v_rcp_f32 v224, v224
    v_rcp_f32 v225, v225
    v_rcp_f32 v226, v226
    v_rcp_f32 v227, v227
    v_rcp_f32 v228, v228
    v_rcp_f32 v229, v229
    v_rcp_f32 v230, v230
    v_rcp_f32 v231, v231
    v_mul_f32 v224, v224, v188
    v_mul_f32 v225, v225, v189
    v_mul_f32 v226, v226, v190
    v_mul_f32 v227, v227, v191
    v_mul_f32 v228, v228, v192
    v_mul_f32 v229, v229, v193
    v_mul_f32 v230, v230, v194
    v_mul_f32 v231, v231, v195
    v_cvt_pk_bf16_f32 v188, v224, v225
    v_cvt_pk_bf16_f32 v189, v226, v227
    v_cvt_pk_bf16_f32 v190, v228, v229
    v_cvt_pk_bf16_f32 v191, v230, v231
    buffer_store_dwordx4 v[188:191], v254, s[36:39], s74 offen offset:1024 sc1
    s_lshl_b32 s50, s43, 12
    s_add_u32 s50, s50, 131072
    v_add_u32 v246, s50, v254
    s_barrier
    ds_read_b128 v[132:135], v246 offset:0
    ds_read_b128 v[136:139], v246 offset:1024
    ds_read_b128 v[140:143], v246 offset:2048
    ds_read_b128 v[144:147], v246 offset:3072
    s_waitcnt lgkmcnt(0)
    v_pk_mul_f32 v[216:217], v[132:133], v[132:133]
    v_pk_mul_f32 v[218:219], v[134:135], v[134:135]
    v_pk_mul_f32 v[220:221], v[136:137], v[136:137]
    v_pk_mul_f32 v[222:223], v[138:139], v[138:139]
    v_pk_fma_f32 v[216:217], v[216:217], v[250:251], v[248:249] op_sel_hi:[1,0,0]
    v_pk_fma_f32 v[218:219], v[218:219], v[250:251], v[248:249] op_sel_hi:[1,0,0]
    v_pk_fma_f32 v[220:221], v[220:221], v[250:251], v[248:249] op_sel_hi:[1,0,0]
    v_pk_fma_f32 v[222:223], v[222:223], v[250:251], v[248:249] op_sel_hi:[1,0,0]
    v_pk_mul_f32 v[216:217], v[216:217], v[132:133]
    v_pk_mul_f32 v[218:219], v[218:219], v[134:135]
    v_pk_mul_f32 v[220:221], v[220:221], v[136:137]
    v_pk_mul_f32 v[222:223], v[222:223], v[138:139]
    v_exp_f32 v216, v216
    v_exp_f32 v217, v217
    v_exp_f32 v218, v218
    v_exp_f32 v219, v219
    v_exp_f32 v220, v220
    v_exp_f32 v221, v221
    v_exp_f32 v222, v222
    v_exp_f32 v223, v223
    v_pk_fma_f32 v[216:217], v[216:217], v[252:253], v[252:253] op_sel_hi:[1,0,0]
    v_pk_fma_f32 v[218:219], v[218:219], v[252:253], v[252:253] op_sel_hi:[1,0,0]
    v_pk_fma_f32 v[220:221], v[220:221], v[252:253], v[252:253] op_sel_hi:[1,0,0]
    v_pk_fma_f32 v[222:223], v[222:223], v[252:253], v[252:253] op_sel_hi:[1,0,0]
    v_rcp_f32 v216, v216
    v_rcp_f32 v217, v217
    v_rcp_f32 v218, v218
    v_rcp_f32 v219, v219
    v_rcp_f32 v220, v220
    v_rcp_f32 v221, v221
    v_rcp_f32 v222, v222
    v_rcp_f32 v223, v223
    v_pk_mul_f32 v[216:217], v[216:217], v[132:133]
    v_pk_mul_f32 v[218:219], v[218:219], v[134:135]
    v_pk_mul_f32 v[220:221], v[220:221], v[136:137]
    v_pk_mul_f32 v[222:223], v[222:223], v[138:139]
    v_cvt_pk_bf16_f32 v132, v216, v217
    v_cvt_pk_bf16_f32 v133, v218, v219
    v_cvt_pk_bf16_f32 v134, v220, v221
    v_cvt_pk_bf16_f32 v135, v222, v223
    buffer_store_dwordx4 v[132:135], v254, s[36:39], s75 offen offset:0 sc1
    v_pk_mul_f32 v[224:225], v[140:141], v[140:141]
    v_pk_mul_f32 v[226:227], v[142:143], v[142:143]
    v_pk_mul_f32 v[228:229], v[144:145], v[144:145]
    v_pk_mul_f32 v[230:231], v[146:147], v[146:147]
    v_pk_fma_f32 v[224:225], v[224:225], v[250:251], v[248:249] op_sel_hi:[1,0,0]
    v_pk_fma_f32 v[226:227], v[226:227], v[250:251], v[248:249] op_sel_hi:[1,0,0]
    v_pk_fma_f32 v[228:229], v[228:229], v[250:251], v[248:249] op_sel_hi:[1,0,0]
    v_pk_fma_f32 v[230:231], v[230:231], v[250:251], v[248:249] op_sel_hi:[1,0,0]
    v_pk_mul_f32 v[224:225], v[224:225], v[140:141]
    v_pk_mul_f32 v[226:227], v[226:227], v[142:143]
    v_pk_mul_f32 v[228:229], v[228:229], v[144:145]
    v_pk_mul_f32 v[230:231], v[230:231], v[146:147]
    v_exp_f32 v224, v224
    v_exp_f32 v225, v225
    v_exp_f32 v226, v226
    v_exp_f32 v227, v227
    v_exp_f32 v228, v228
    v_exp_f32 v229, v229
    v_exp_f32 v230, v230
    v_exp_f32 v231, v231
    v_pk_fma_f32 v[224:225], v[224:225], v[252:253], v[252:253] op_sel_hi:[1,0,0]
    v_pk_fma_f32 v[226:227], v[226:227], v[252:253], v[252:253] op_sel_hi:[1,0,0]
    v_pk_fma_f32 v[228:229], v[228:229], v[252:253], v[252:253] op_sel_hi:[1,0,0]
    v_pk_fma_f32 v[230:231], v[230:231], v[252:253], v[252:253] op_sel_hi:[1,0,0]
    v_rcp_f32 v224, v224
    v_rcp_f32 v225, v225
    v_rcp_f32 v226, v226
    v_rcp_f32 v227, v227
    v_rcp_f32 v228, v228
    v_rcp_f32 v229, v229
    v_rcp_f32 v230, v230
    v_rcp_f32 v231, v231
    v_pk_mul_f32 v[224:225], v[224:225], v[140:141]
    v_pk_mul_f32 v[226:227], v[226:227], v[142:143]
    v_pk_mul_f32 v[228:229], v[228:229], v[144:145]
    v_pk_mul_f32 v[230:231], v[230:231], v[146:147]
    v_cvt_pk_bf16_f32 v140, v224, v225
    v_cvt_pk_bf16_f32 v141, v226, v227
    v_cvt_pk_bf16_f32 v142, v228, v229
    v_cvt_pk_bf16_f32 v143, v230, v231
    buffer_store_dwordx4 v[140:143], v254, s[36:39], s75 offen offset:1024 sc1
    s_waitcnt vmcnt(4)
L_p1join_12:
    s_branch L_p1end_3
L_mainB_5:
    v_mul_u32_u24 v242, 3584, v212
    v_add3_u32 v242, v242, v217, s75
    v_and_b32 v212, 31, v0
    v_lshlrev_b32 v212, 1, v212
    s_lshl_b32 s50, s44, 6
    s_add_u32 s74, s74, s50
    s_add_u32 s75, s75, s50
    buffer_load_ushort v249, v212, s[20:23], s74 offen
    buffer_load_ushort v251, v212, s[20:23], s75 offen
    s_lshl_b32 s50, s44, 1
    s_xor_b32 s49, s43, s50
    v_and_b32 v212, 31, v0
    v_lshrrev_b32 v213, 5, v0
    v_bfe_u32 v214, v0, 1, 3
    v_xor_b32 v214, v214, v213
    s_lshl_b32 s50, s49, 1
    v_xor_b32 v214, s50, v214
    v_lshlrev_b32 v214, 4, v214
    v_lshl_add_u32 v214, v212, 7, v214
    s_lshl_b32 s50, s43, 12
    v_add_u32 v192, s50, v214
    v_xor_b32 v193, 32, v192
    v_xor_b32 v194, 64, v192
    v_xor_b32 v195, 96, v192
    v_bfe_u32 v214, v0, 2, 2
    v_lshl_add_u32 v215, v213, 3, v214
    v_lshrrev_b32 v214, 1, v214
    v_xor_b32 v214, s44, v214
    v_lshlrev_b32 v214, 6, v214
    v_lshl_add_u32 v214, v215, 7, v214
    v_bfe_u32 v216, v0, 4, 1
    v_lshl_add_u32 v214, v216, 5, v214
    v_and_b32 v217, 3, v0
    v_lshl_add_u32 v214, v217, 3, v214
    s_lshl_b32 s50, s49, 11
    v_add_u32 v2, s50, v214
    v_xor_b32 v3, 2048, v2
    v_xor_b32 v236, 4096, v2
    v_xor_b32 v237, 6144, v2
    v_bfe_u32 v214, v0, 2, 1
    v_xor_b32 v214, v214, v216
    v_or_b32 v214, v214, v217
    v_cmp_eq_u32 vcc, 0, v214
    v_mov_b32 v215, 0x3f003f00
    s_nop 0
    v_cndmask_b32 v200, 0, v215, vcc
    v_mov_b32 v201, v200
    v_mov_b32 v202, v200
    v_mov_b32 v203, v200
    s_mov_b32 s59, 0xffff0000
    s_mov_b32 s62, 0x03020302
    s_mov_b32 s63, 0x07060302
    s_mov_b32 s64, 0x01000100
    v_lshlrev_b32 v255, 2, v0
    v_mov_b32 v214, 151552
    v_mov_b32 v215, 0
    ds_write_b32 v214, v215
    s_lshr_b32 s71, s46, 3
    s_lshl_b32 s68, s45, 2
    s_add_u32 s68, s68, s71
    s_lshl_b32 s70, s69, 3
    s_add_u32 s70, s70, s45
    s_waitcnt vmcnt(8)
    s_barrier
    ds_read_b128 v[4:7], v192 offset:0
    ds_read_b64_tr_b16 v[164:165], v2 offset:16384
    ds_read_b64_tr_b16 v[166:167], v2 offset:16896
    ds_read_b64_tr_b16 v[168:169], v2 offset:24576
    ds_read_b64_tr_b16 v[170:171], v2 offset:25088
    ds_read_b128 v[8:11], v193 offset:0
    ds_read_b64_tr_b16 v[172:173], v3 offset:16384
    ds_read_b64_tr_b16 v[174:175], v3 offset:16896
    ds_read_b64_tr_b16 v[176:177], v3 offset:24576
    ds_read_b64_tr_b16 v[178:179], v3 offset:25088
    s_waitcnt lgkmcnt(5)
    v_mfma_f32_32x32x16_bf16 v[132:147], v[4:7], v[164:167], 0
    ds_read_b128 v[12:15], v194 offset:0
    ds_read_b64_tr_b16 v[212:213], v236 offset:16384
    ds_read_b64_tr_b16 v[214:215], v236 offset:16896
    v_mfma_f32_16x16x32_bf16 v[196:199], v[200:203], v[164:167], 0
    v_mfma_f32_32x32x16_bf16 v[148:163], v[168:171], v[4:7], 0
    ds_read_b64_tr_b16 v[216:217], v236 offset:24576
    ds_read_b64_tr_b16 v[218:219], v236 offset:25088
    s_add_u32 m0, s66, 0x10000
    s_add_u32 s41, s40, 2
    s_and_b32 s41, s41, 7
    s_mul_i32 s52, s41, 0x80
    buffer_load_dwordx4 v238, s[4:7], s52 offen lds
    s_add_u32 m0, s66, 0x10000
    s_mul_i32 s52, s41, 0x80
    buffer_load_dwordx4 v239, s[4:7], s52 offen offset:1024 lds
    v_mfma_f32_16x16x32_bf16 v[188:191], v[200:203], v[168:171], 0
    s_waitcnt lgkmcnt(5)
    v_mfma_f32_32x32x16_bf16 v[132:147], v[8:11], v[172:175], v[132:147]
    ds_read_b128 v[16:19], v195 offset:0
    ds_read_b64_tr_b16 v[164:165], v237 offset:16384
    ds_read_b64_tr_b16 v[166:167], v237 offset:16896
    v_mfma_f32_32x32x16_bf16 v[148:163], v[176:179], v[8:11], v[148:163]
    ds_read_b64_tr_b16 v[168:169], v237 offset:24576
    ds_read_b64_tr_b16 v[170:171], v237 offset:25088
    s_add_u32 m0, s67, 0x14000
    s_mul_i32 s52, s41, 0x30000
    buffer_load_dwordx4 v240, s[8:11], s52 offen lds
    s_add_u32 m0, s67, 0x16000
    s_mul_i32 s52, s41, 0x38000
    buffer_load_dwordx4 v241, s[16:19], s52 offen lds
    s_waitcnt lgkmcnt(5)
    v_mfma_f32_32x32x16_bf16 v[132:147], v[12:15], v[212:215], v[132:147]
    s_waitcnt vmcnt(6)
    s_barrier
    ds_read_b128 v[20:23], v192 offset:32768
    ds_read_b64_tr_b16 v[172:173], v2 offset:49152
    ds_read_b64_tr_b16 v[174:175], v2 offset:49664
    v_mfma_f32_32x32x16_bf16 v[148:163], v[216:219], v[12:15], v[148:163]
    ds_read_b64_tr_b16 v[176:177], v2 offset:57344
    ds_read_b64_tr_b16 v[178:179], v2 offset:57856
    s_add_u32 m0, s66, 0x18000
    s_add_u32 s41, s40, 3
    s_and_b32 s41, s41, 7
    s_mul_i32 s52, s41, 0x80
    buffer_load_dwordx4 v238, s[4:7], s52 offen lds
    s_waitcnt lgkmcnt(5)
    v_mfma_f32_32x32x16_bf16 v[132:147], v[16:19], v[164:167], v[132:147]
    ds_read_b128 v[24:27], v193 offset:32768
    ds_read_b64_tr_b16 v[212:213], v3 offset:49152
    ds_read_b64_tr_b16 v[214:215], v3 offset:49664
    v_readfirstlane_b32 s78, v228
    v_lshlrev_b32 v229, 16, v220
    v_and_b32 v230, s59, v220
    v_add_f32 v224, v229, v230
    v_mfma_f32_32x32x16_bf16 v[148:163], v[168:171], v[16:19], v[148:163]
    ds_read_b64_tr_b16 v[216:217], v3 offset:57344
    ds_read_b64_tr_b16 v[218:219], v3 offset:57856
    s_add_u32 m0, s66, 0x18000
    s_mul_i32 s52, s41, 0x80
    buffer_load_dwordx4 v239, s[4:7], s52 offen offset:1024 lds
    v_mul_f32 v226, v229, v229
    s_add_u32 s78, s78, 1
    v_fmac_f32 v226, v230, v230
    v_lshlrev_b32 v229, 16, v221
    s_waitcnt lgkmcnt(5)
    v_mfma_f32_32x32x16_bf16 v[132:147], v[20:23], v[172:175], v[132:147]
    ds_read_b128 v[28:31], v194 offset:32768
    ds_read_b64_tr_b16 v[164:165], v236 offset:49152
    ds_read_b64_tr_b16 v[166:167], v236 offset:49664
    v_and_b32 v230, s59, v221
    v_add_f32 v224, v224, v229
    v_fmac_f32 v226, v229, v229
    v_add_f32 v224, v224, v230
    v_mfma_f32_16x16x32_bf16 v[196:199], v[200:203], v[172:175], v[196:199]
    v_mfma_f32_32x32x16_bf16 v[148:163], v[176:179], v[20:23], v[148:163]
    ds_read_b64_tr_b16 v[168:169], v236 offset:57344
    ds_read_b64_tr_b16 v[170:171], v236 offset:57856
    s_add_u32 m0, s67, 0x1c000
    s_mul_i32 s52, s41, 0x30000
    buffer_load_dwordx4 v240, s[8:11], s52 offen lds
    v_fmac_f32 v226, v230, v230
    v_lshlrev_b32 v229, 16, v222
    v_and_b32 v230, s59, v222
    v_add_f32 v224, v224, v229
    v_mfma_f32_16x16x32_bf16 v[188:191], v[200:203], v[176:179], v[188:191]
    s_waitcnt lgkmcnt(5)
    v_mfma_f32_32x32x16_bf16 v[132:147], v[24:27], v[212:215], v[132:147]
    ds_read_b128 v[32:35], v195 offset:32768
    ds_read_b64_tr_b16 v[172:173], v237 offset:49152
    ds_read_b64_tr_b16 v[174:175], v237 offset:49664
    v_fmac_f32 v226, v229, v229
    v_add_f32 v224, v224, v230
    v_fmac_f32 v226, v230, v230
    v_lshlrev_b32 v229, 16, v223
    v_mfma_f32_32x32x16_bf16 v[148:163], v[216:219], v[24:27], v[148:163]
    ds_read_b64_tr_b16 v[176:177], v237 offset:57344
    ds_read_b64_tr_b16 v[178:179], v237 offset:57856
    s_add_u32 m0, s67, 0x1e000
    s_mul_i32 s52, s41, 0x38000
    buffer_load_dwordx4 v241, s[16:19], s52 offen lds
    v_and_b32 v230, s59, v223
    v_add_f32 v224, v224, v229
    v_fmac_f32 v226, v229, v229
    v_add_f32 v224, v224, v230
    s_waitcnt lgkmcnt(5)
    v_mfma_f32_32x32x16_bf16 v[132:147], v[28:31], v[164:167], v[132:147]
    s_waitcnt vmcnt(4)
    s_barrier
    v_add_u32 v192, 0x10000, v192
    v_add_u32 v193, 0x10000, v193
    v_add_u32 v194, 0x10000, v194
    v_add_u32 v195, 0x10000, v195
    v_add_u32 v2, 0x10000, v2
    v_add_u32 v3, 0x10000, v3
    v_add_u32 v236, 0x10000, v236
    v_add_u32 v237, 0x10000, v237
    ds_read_b128 v[36:39], v192 offset:0
    ds_read_b64_tr_b16 v[212:213], v2 offset:16384
    ds_read_b64_tr_b16 v[214:215], v2 offset:16896
    v_fmac_f32 v226, v230, v230
    v_mov_b32 v225, s78
    v_add_f32_dpp v224, v224, v224 row_shr:1 row_mask:0xf bank_mask:0xf bound_ctrl:1
    v_add_f32_dpp v226, v226, v226 row_shr:1 row_mask:0xf bank_mask:0xf bound_ctrl:1
    v_mfma_f32_32x32x16_bf16 v[148:163], v[168:171], v[28:31], v[148:163]
    ds_read_b64_tr_b16 v[216:217], v2 offset:24576
    ds_read_b64_tr_b16 v[218:219], v2 offset:25088
    s_add_u32 m0, s66, 0x0
    s_add_u32 s41, s40, 4
    s_and_b32 s41, s41, 7
    s_mul_i32 s52, s41, 0x80
    buffer_load_dwordx4 v238, s[4:7], s52 offen lds
    v_mov_b32 v227, s78
    v_add_f32_dpp v224, v224, v224 row_shr:2 row_mask:0xf bank_mask:0xf bound_ctrl:1
    v_add_f32_dpp v226, v226, v226 row_shr:2 row_mask:0xf bank_mask:0xf bound_ctrl:1
    s_lshl_b32 s60, s60, 4
    s_waitcnt lgkmcnt(5)
    v_mfma_f32_32x32x16_bf16 v[132:147], v[32:35], v[172:175], v[132:147]
    ds_read_b128 v[40:43], v193 offset:0
    ds_read_b64_tr_b16 v[164:165], v3 offset:16384
    ds_read_b64_tr_b16 v[166:167], v3 offset:16896
    v_add_f32_dpp v224, v224, v224 row_shr:4 row_mask:0xf bank_mask:0xf bound_ctrl:1
    v_add_f32_dpp v226, v226, v226 row_shr:4 row_mask:0xf bank_mask:0xf bound_ctrl:1
    s_add_u32 s60, s60, 0x1300000
    v_add_f32_dpp v224, v224, v224 row_shr:8 row_mask:0xf bank_mask:0xf bound_ctrl:1
    v_mfma_f32_32x32x16_bf16 v[148:163], v[176:179], v[32:35], v[148:163]
    ds_read_b64_tr_b16 v[168:169], v3 offset:24576
    ds_read_b64_tr_b16 v[170:171], v3 offset:25088
    s_add_u32 m0, s66, 0x0
    s_mul_i32 s52, s41, 0x80
    buffer_load_dwordx4 v239, s[4:7], s52 offen offset:1024 lds
    v_add_f32_dpp v226, v226, v226 row_shr:8 row_mask:0xf bank_mask:0xf bound_ctrl:1
    s_nop 0
    v_add_f32_dpp v224, v224, v224 row_bcast:15 row_mask:0xa bank_mask:0xf
    v_add_f32_dpp v226, v226, v226 row_bcast:15 row_mask:0xa bank_mask:0xf
    s_waitcnt lgkmcnt(5)
    v_mfma_f32_32x32x16_bf16 v[132:147], v[36:39], v[212:215], v[132:147]
    ds_read_b128 v[44:47], v194 offset:0
    ds_read_b64_tr_b16 v[172:173], v236 offset:16384
    ds_read_b64_tr_b16 v[174:175], v236 offset:16896
    s_nop 0
    v_add_f32_dpp v224, v224, v224 row_bcast:31 row_mask:0xc bank_mask:0xf
    v_add_f32_dpp v226, v226, v226 row_bcast:31 row_mask:0xc bank_mask:0xf
    v_mfma_f32_16x16x32_bf16 v[196:199], v[200:203], v[212:215], v[196:199]
    v_mfma_f32_32x32x16_bf16 v[148:163], v[216:219], v[36:39], v[148:163]
    ds_read_b64_tr_b16 v[176:177], v236 offset:24576
    ds_read_b64_tr_b16 v[178:179], v236 offset:25088
    s_add_u32 m0, s67, 0x4000
    s_mul_i32 s52, s41, 0x30000
    buffer_load_dwordx4 v240, s[8:11], s52 offen lds
    v_mfma_f32_16x16x32_bf16 v[188:191], v[200:203], v[216:219], v[188:191]
    s_mov_b32 exec_lo, 0
    s_mov_b32 exec_hi, 0x80000000
    buffer_store_dwordx4 v[224:227], off, s[36:39], s60 sc1
    s_mov_b64 exec, -1
    s_waitcnt lgkmcnt(5)
    v_mfma_f32_32x32x16_bf16 v[132:147], v[40:43], v[164:167], v[132:147]
    ds_read_b128 v[48:51], v195 offset:0
    ds_read_b64_tr_b16 v[212:213], v237 offset:16384
    ds_read_b64_tr_b16 v[214:215], v237 offset:16896
    v_mfma_f32_32x32x16_bf16 v[148:163], v[168:171], v[40:43], v[148:163]
    ds_read_b64_tr_b16 v[216:217], v237 offset:24576
    ds_read_b64_tr_b16 v[218:219], v237 offset:25088
    s_add_u32 m0, s67, 0x6000
    s_mul_i32 s52, s41, 0x38000
    buffer_load_dwordx4 v241, s[16:19], s52 offen lds
    s_waitcnt lgkmcnt(5)
    v_mfma_f32_32x32x16_bf16 v[132:147], v[44:47], v[172:175], v[132:147]
    s_waitcnt vmcnt(5)
    s_barrier
    ds_read_b128 v[52:55], v192 offset:32768
    ds_read_b64_tr_b16 v[164:165], v2 offset:49152
    ds_read_b64_tr_b16 v[166:167], v2 offset:49664
    v_mfma_f32_32x32x16_bf16 v[148:163], v[176:179], v[44:47], v[148:163]
    ds_read_b64_tr_b16 v[168:169], v2 offset:57344
    ds_read_b64_tr_b16 v[170:171], v2 offset:57856
    s_add_u32 m0, s66, 0x8000
    s_add_u32 s41, s40, 5
    s_and_b32 s41, s41, 7
    s_mul_i32 s52, s41, 0x80
    buffer_load_dwordx4 v238, s[4:7], s52 offen lds
    s_waitcnt lgkmcnt(5)
    v_mfma_f32_32x32x16_bf16 v[132:147], v[48:51], v[212:215], v[132:147]
    ds_read_b128 v[56:59], v193 offset:32768
    ds_read_b64_tr_b16 v[172:173], v3 offset:49152
    ds_read_b64_tr_b16 v[174:175], v3 offset:49664
    v_mfma_f32_32x32x16_bf16 v[148:163], v[216:219], v[48:51], v[148:163]
    ds_read_b64_tr_b16 v[176:177], v3 offset:57344
    ds_read_b64_tr_b16 v[178:179], v3 offset:57856
    s_add_u32 m0, s66, 0x8000
    s_mul_i32 s52, s41, 0x80
    buffer_load_dwordx4 v239, s[4:7], s52 offen offset:1024 lds
    s_waitcnt lgkmcnt(5)
    v_mfma_f32_32x32x16_bf16 v[132:147], v[52:55], v[164:167], v[132:147]
    ds_read_b128 v[60:63], v194 offset:32768
    ds_read_b64_tr_b16 v[212:213], v236 offset:49152
    ds_read_b64_tr_b16 v[214:215], v236 offset:49664
    v_mfma_f32_16x16x32_bf16 v[196:199], v[200:203], v[164:167], v[196:199]
    v_mfma_f32_32x32x16_bf16 v[148:163], v[168:171], v[52:55], v[148:163]
    ds_read_b64_tr_b16 v[216:217], v236 offset:57344
    ds_read_b64_tr_b16 v[218:219], v236 offset:57856
    s_add_u32 m0, s67, 0xc000
    s_mul_i32 s52, s41, 0x30000
    buffer_load_dwordx4 v240, s[8:11], s52 offen lds
    v_mfma_f32_16x16x32_bf16 v[188:191], v[200:203], v[168:171], v[188:191]
    s_waitcnt lgkmcnt(5)
    v_mfma_f32_32x32x16_bf16 v[132:147], v[56:59], v[172:175], v[132:147]
    ds_read_b128 v[64:67], v195 offset:32768
    ds_read_b64_tr_b16 v[164:165], v237 offset:49152
    ds_read_b64_tr_b16 v[166:167], v237 offset:49664
    v_mfma_f32_32x32x16_bf16 v[148:163], v[176:179], v[56:59], v[148:163]
    ds_read_b64_tr_b16 v[168:169], v237 offset:57344
    ds_read_b64_tr_b16 v[170:171], v237 offset:57856
    s_add_u32 m0, s67, 0xe000
    s_mul_i32 s52, s41, 0x38000
    buffer_load_dwordx4 v241, s[16:19], s52 offen lds
    s_waitcnt lgkmcnt(5)
    v_mfma_f32_32x32x16_bf16 v[132:147], v[60:63], v[212:215], v[132:147]
    s_waitcnt vmcnt(4)
    s_barrier
    v_add_u32 v192, 0xffff0000, v192
    v_add_u32 v193, 0xffff0000, v193
    v_add_u32 v194, 0xffff0000, v194
    v_add_u32 v195, 0xffff0000, v195
    v_add_u32 v2, 0xffff0000, v2
    v_add_u32 v3, 0xffff0000, v3
    v_add_u32 v236, 0xffff0000, v236
    v_add_u32 v237, 0xffff0000, v237
    ds_read_b128 v[68:71], v192 offset:0
    ds_read_b64_tr_b16 v[172:173], v2 offset:16384
    ds_read_b64_tr_b16 v[174:175], v2 offset:16896
    v_mfma_f32_32x32x16_bf16 v[148:163], v[216:219], v[60:63], v[148:163]
    ds_read_b64_tr_b16 v[176:177], v2 offset:24576
    ds_read_b64_tr_b16 v[178:179], v2 offset:25088
    s_add_u32 m0, s66, 0x10000
    s_add_u32 s41, s40, 6
    s_and_b32 s41, s41, 7
    s_mul_i32 s52, s41, 0x80
    buffer_load_dwordx4 v238, s[4:7], s52 offen lds
    s_waitcnt lgkmcnt(5)
    v_mfma_f32_32x32x16_bf16 v[132:147], v[64:67], v[164:167], v[132:147]
    ds_read_b128 v[72:75], v193 offset:0
    ds_read_b64_tr_b16 v[212:213], v3 offset:16384
    ds_read_b64_tr_b16 v[214:215], v3 offset:16896
    v_mfma_f32_32x32x16_bf16 v[148:163], v[168:171], v[64:67], v[148:163]
    ds_read_b64_tr_b16 v[216:217], v3 offset:24576
    ds_read_b64_tr_b16 v[218:219], v3 offset:25088
    s_add_u32 m0, s66, 0x10000
    s_mul_i32 s52, s41, 0x80
    buffer_load_dwordx4 v239, s[4:7], s52 offen offset:1024 lds
    s_waitcnt lgkmcnt(5)
    v_mfma_f32_32x32x16_bf16 v[132:147], v[68:71], v[172:175], v[132:147]
    ds_read_b128 v[76:79], v194 offset:0
    ds_read_b64_tr_b16 v[164:165], v236 offset:16384
    ds_read_b64_tr_b16 v[166:167], v236 offset:16896
    v_mfma_f32_16x16x32_bf16 v[196:199], v[200:203], v[172:175], v[196:199]
    v_mfma_f32_32x32x16_bf16 v[148:163], v[176:179], v[68:71], v[148:163]
    ds_read_b64_tr_b16 v[168:169], v236 offset:24576
    ds_read_b64_tr_b16 v[170:171], v236 offset:25088
    s_add_u32 m0, s67, 0x14000
    s_mul_i32 s52, s41, 0x30000
    buffer_load_dwordx4 v240, s[8:11], s52 offen lds
    v_mfma_f32_16x16x32_bf16 v[188:191], v[200:203], v[176:179], v[188:191]
    s_waitcnt lgkmcnt(5)
    v_mfma_f32_32x32x16_bf16 v[132:147], v[72:75], v[212:215], v[132:147]
    ds_read_b128 v[80:83], v195 offset:0
    ds_read_b64_tr_b16 v[172:173], v237 offset:16384
    ds_read_b64_tr_b16 v[174:175], v237 offset:16896
    v_mfma_f32_32x32x16_bf16 v[148:163], v[216:219], v[72:75], v[148:163]
    ds_read_b64_tr_b16 v[176:177], v237 offset:24576
    ds_read_b64_tr_b16 v[178:179], v237 offset:25088
    s_add_u32 m0, s67, 0x16000
    s_mul_i32 s52, s41, 0x38000
    buffer_load_dwordx4 v241, s[16:19], s52 offen lds
    s_waitcnt lgkmcnt(5)
    v_mfma_f32_32x32x16_bf16 v[132:147], v[76:79], v[164:167], v[132:147]
    s_waitcnt vmcnt(4)
    s_barrier
    ds_read_b128 v[84:87], v192 offset:32768
    ds_read_b64_tr_b16 v[212:213], v2 offset:49152
    ds_read_b64_tr_b16 v[214:215], v2 offset:49664
    v_mfma_f32_32x32x16_bf16 v[148:163], v[168:171], v[76:79], v[148:163]
    ds_read_b64_tr_b16 v[216:217], v2 offset:57344
    ds_read_b64_tr_b16 v[218:219], v2 offset:57856
    s_add_u32 m0, s66, 0x18000
    s_add_u32 s41, s40, 7
    s_and_b32 s41, s41, 7
    s_mul_i32 s52, s41, 0x80
    buffer_load_dwordx4 v238, s[4:7], s52 offen lds
    s_waitcnt lgkmcnt(5)
    v_mfma_f32_32x32x16_bf16 v[132:147], v[80:83], v[172:175], v[132:147]
    ds_read_b128 v[88:91], v193 offset:32768
    ds_read_b64_tr_b16 v[164:165], v3 offset:49152
    ds_read_b64_tr_b16 v[166:167], v3 offset:49664
    v_mfma_f32_32x32x16_bf16 v[148:163], v[176:179], v[80:83], v[148:163]
    ds_read_b64_tr_b16 v[168:169], v3 offset:57344
    ds_read_b64_tr_b16 v[170:171], v3 offset:57856
    s_add_u32 m0, s66, 0x18000
    s_mul_i32 s52, s41, 0x80
    buffer_load_dwordx4 v239, s[4:7], s52 offen offset:1024 lds
    s_lshl_b32 s80, s47, 2
    s_add_u32 s80, s80, s43
    s_lshl_b32 s80, s80, 9
    s_add_u32 s80, s80, 0x1300000
    v_and_b32 v228, 0x1ff, v254
    buffer_load_dwordx4 v[224:227], v228, s[36:39], s80 offen sc1
    s_waitcnt lgkmcnt(5)
    v_mfma_f32_32x32x16_bf16 v[132:147], v[84:87], v[212:215], v[132:147]
    ds_read_b128 v[92:95], v194 offset:32768
    ds_read_b64_tr_b16 v[172:173], v236 offset:49152
    ds_read_b64_tr_b16 v[174:175], v236 offset:49664
    v_mfma_f32_16x16x32_bf16 v[196:199], v[200:203], v[212:215], v[196:199]
    v_mfma_f32_32x32x16_bf16 v[148:163], v[216:219], v[84:87], v[148:163]
    ds_read_b64_tr_b16 v[176:177], v236 offset:57344
    ds_read_b64_tr_b16 v[178:179], v236 offset:57856
    s_add_u32 m0, s67, 0x1c000
    s_mul_i32 s52, s41, 0x30000
    buffer_load_dwordx4 v240, s[8:11], s52 offen lds
    v_mfma_f32_16x16x32_bf16 v[188:191], v[200:203], v[216:219], v[188:191]
    s_waitcnt lgkmcnt(5)
    v_mfma_f32_32x32x16_bf16 v[132:147], v[88:91], v[164:167], v[132:147]
    ds_read_b128 v[96:99], v195 offset:32768
    ds_read_b64_tr_b16 v[212:213], v237 offset:49152
    ds_read_b64_tr_b16 v[214:215], v237 offset:49664
    v_mfma_f32_32x32x16_bf16 v[148:163], v[168:171], v[88:91], v[148:163]
    ds_read_b64_tr_b16 v[216:217], v237 offset:57344
    ds_read_b64_tr_b16 v[218:219], v237 offset:57856
    s_add_u32 m0, s67, 0x1e000
    s_mul_i32 s52, s41, 0x38000
    buffer_load_dwordx4 v241, s[16:19], s52 offen lds
    s_waitcnt lgkmcnt(5)
    v_mfma_f32_32x32x16_bf16 v[132:147], v[92:95], v[172:175], v[132:147]
    s_waitcnt vmcnt(5)
    s_barrier
    v_add_u32 v192, 0x10000, v192
    v_add_u32 v193, 0x10000, v193
    v_add_u32 v194, 0x10000, v194
    v_add_u32 v195, 0x10000, v195
    v_add_u32 v2, 0x10000, v2
    v_add_u32 v3, 0x10000, v3
    v_add_u32 v236, 0x10000, v236
    v_add_u32 v237, 0x10000, v237
    ds_read_b128 v[100:103], v192 offset:0
    ds_read_b64_tr_b16 v[164:165], v2 offset:16384
    ds_read_b64_tr_b16 v[166:167], v2 offset:16896
    v_mfma_f32_32x32x16_bf16 v[148:163], v[176:179], v[92:95], v[148:163]
    ds_read_b64_tr_b16 v[168:169], v2 offset:24576
    ds_read_b64_tr_b16 v[170:171], v2 offset:25088
    s_add_u32 m0, s67, 0x0
    s_add_u32 s41, s40, 0
    s_and_b32 s41, s41, 7
    s_mul_i32 s52, s41, 0x38000
    buffer_load_dwordx4 v242, s[16:19], s52 offen lds
    s_waitcnt lgkmcnt(5)
    v_mfma_f32_32x32x16_bf16 v[132:147], v[96:99], v[212:215], v[132:147]
    ds_read_b128 v[104:107], v193 offset:0
    ds_read_b64_tr_b16 v[172:173], v3 offset:16384
    ds_read_b64_tr_b16 v[174:175], v3 offset:16896
    v_mfma_f32_32x32x16_bf16 v[148:163], v[216:219], v[96:99], v[148:163]
    ds_read_b64_tr_b16 v[176:177], v3 offset:24576
    ds_read_b64_tr_b16 v[178:179], v3 offset:25088
    s_add_u32 m0, s67, 0x2000
    s_add_u32 s41, s40, 1
    s_and_b32 s41, s41, 7
    s_mul_i32 s52, s41, 0x38000
    buffer_load_dwordx4 v242, s[16:19], s52 offen lds
    s_lshl_b32 s54, s47, 2
    s_add_u32 s54, s54, s43
    s_lshl_b32 s55, s48, 2
    s_lshl_b32 s50, s44, 1
    s_add_u32 s55, s55, s50
    s_lshl_b32 s50, s55, 16
    s_lshl_b32 s51, s54, 10
    s_add_u32 s60, s50, s51
    s_add_u32 s61, s60, 65536
    s_mul_i32 s50, s54, 114688
    s_add_u32 s50, s50, 0x800000
    s_lshl_b32 s74, s74, 5
    s_add_u32 s74, s74, s50
    s_lshl_b32 s75, s75, 5
    s_add_u32 s75, s75, s50
    v_bfe_u32 v220, v0, 4, 1
    v_lshlrev_b32 v220, 16, v220
    v_lshrrev_b32 v221, 5, v0
    v_lshl_add_u32 v220, v221, 8, v220
    v_and_b32 v221, 15, v0
    v_lshl_add_u32 v220, v221, 4, v220
    v_add_u32 v238, 0x400000, v220
    s_waitcnt lgkmcnt(5)
    v_mfma_f32_32x32x16_bf16 v[132:147], v[100:103], v[164:167], v[132:147]
    ds_read_b128 v[108:111], v194 offset:0
    ds_read_b64_tr_b16 v[212:213], v236 offset:16384
    ds_read_b64_tr_b16 v[214:215], v236 offset:16896
    v_mfma_f32_16x16x32_bf16 v[196:199], v[200:203], v[164:167], v[196:199]
    v_mfma_f32_32x32x16_bf16 v[148:163], v[168:171], v[100:103], v[148:163]
    ds_read_b64_tr_b16 v[216:217], v236 offset:24576
    ds_read_b64_tr_b16 v[218:219], v236 offset:25088
    s_add_u32 m0, s67, 0x4000
    s_add_u32 s41, s40, 2
    s_and_b32 s41, s41, 7
    s_mul_i32 s52, s41, 0x38000
    buffer_load_dwordx4 v242, s[16:19], s52 offen lds
    v_mfma_f32_16x16x32_bf16 v[188:191], v[200:203], v[168:171], v[188:191]
    s_waitcnt vmcnt(5)
    s_mov_b32 s79, 0x40000
L_rs_20:
    v_cmp_ne_u32 vcc, s78, v225
    v_cmp_ne_u32 s[50:51], s78, v227
    s_nop 0
    s_or_b64 vcc, vcc, s[50:51]
    s_cbranch_vccz L_rsd_21
    buffer_load_dwordx4 v[224:227], v228, s[36:39], s80 offen sc1
    s_sub_u32 s79, s79, 1
    s_cmp_lg_u32 s79, 0
    s_waitcnt vmcnt(0)
    s_cbranch_scc1 L_rs_20
L_rsd_21:
    s_waitcnt lgkmcnt(5)
    v_mfma_f32_32x32x16_bf16 v[132:147], v[104:107], v[172:175], v[132:147]
    ds_read_b128 v[112:115], v195 offset:0
    ds_read_b64_tr_b16 v[164:165], v237 offset:16384
    ds_read_b64_tr_b16 v[166:167], v237 offset:16896
    v_mul_f32 v244, 0xbb000000, v224
    v_mov_b32 v231, 0x3b000000
    v_mul_f32 v230, v244, v244
    v_and_b32 v229, s59, v244
    v_mfma_f32_32x32x16_bf16 v[148:163], v[176:179], v[104:107], v[148:163]
    ds_read_b64_tr_b16 v[168:169], v237 offset:24576
    ds_read_b64_tr_b16 v[170:171], v237 offset:25088
    s_add_u32 m0, s67, 0x6000
    s_add_u32 s41, s40, 3
    s_and_b32 s41, s41, 7
    s_mul_i32 s52, s41, 0x38000
    buffer_load_dwordx4 v242, s[16:19], s52 offen lds
    v_fma_f32 v245, v226, v231, -v230
    v_sub_f32 v229, v244, v229
    v_max_f32 v245, 0, v245
    v_perm_b32 v204, v229, v244, s63
    s_waitcnt lgkmcnt(5)
    v_mfma_f32_32x32x16_bf16 v[132:147], v[108:111], v[212:215], v[132:147]
    s_waitcnt vmcnt(4)
    s_barrier
    ds_read_b128 v[116:119], v192 offset:32768
    ds_read_b64_tr_b16 v[172:173], v2 offset:49152
    ds_read_b64_tr_b16 v[174:175], v2 offset:49664
    v_add_f32 v230, 0x3727c5ac, v245
    v_mov_b32 v205, v204
    v_rcp_f32 v231, v230
    v_rsq_f32 v253, v230
    v_mfma_f32_32x32x16_bf16 v[148:163], v[216:219], v[108:111], v[148:163]
    ds_read_b64_tr_b16 v[176:177], v2 offset:57344
    ds_read_b64_tr_b16 v[178:179], v2 offset:57856
    s_add_u32 m0, s67, 0x8000
    s_add_u32 s41, s40, 4
    s_and_b32 s41, s41, 7
    s_mul_i32 s52, s41, 0x38000
    buffer_load_dwordx4 v242, s[16:19], s52 offen lds
    v_mov_b32 v207, 0
    v_mul_f32 v231, v245, v231
    v_add_f32 v231, 0x3727c5ac, v231
    v_mul_f32 v231, v231, v230
    s_waitcnt lgkmcnt(5)
    v_mfma_f32_32x32x16_bf16 v[132:147], v[112:115], v[164:167], v[132:147]
    ds_read_b128 v[120:123], v193 offset:32768
    ds_read_b64_tr_b16 v[212:213], v3 offset:49152
    ds_read_b64_tr_b16 v[214:215], v3 offset:49664
    v_sqrt_f32 v252, v231
    v_rsq_f32 v250, v231
    v_mul_f32 v231, 0.5, v252
    v_mul_f32 v248, 0xc0135761, v250
    v_mfma_f32_32x32x16_bf16 v[148:163], v[168:171], v[112:115], v[148:163]
    ds_read_b64_tr_b16 v[216:217], v3 offset:57344
    ds_read_b64_tr_b16 v[218:219], v3 offset:57856
    s_add_u32 m0, s67, 0xa000
    s_add_u32 s41, s40, 5
    s_and_b32 s41, s41, 7
    s_mul_i32 s52, s41, 0x38000
    buffer_load_dwordx4 v242, s[16:19], s52 offen lds
    v_and_b32 v230, s59, v231
    v_mul_f32 v250, v250, v250
    v_sub_f32 v230, v231, v230
    v_mul_f32 v250, 0x3d372713, v250
    s_waitcnt lgkmcnt(5)
    v_mfma_f32_32x32x16_bf16 v[132:147], v[116:119], v[172:175], v[132:147]
    ds_read_b128 v[124:127], v194 offset:32768
    ds_read_b64_tr_b16 v[164:165], v236 offset:49152
    ds_read_b64_tr_b16 v[166:167], v236 offset:49664
    v_perm_b32 v206, v230, v231, s63
    v_mul_f32 v250, v248, v250
    v_mul_f32 v231, 0.5, v253
    v_mov_b32 v234, 0
    v_mfma_f32_16x16x32_bf16 v[196:199], v[200:203], v[172:175], v[196:199]
    v_mfma_f32_32x32x16_bf16 v[148:163], v[176:179], v[116:119], v[148:163]
    ds_read_b64_tr_b16 v[168:169], v236 offset:57344
    ds_read_b64_tr_b16 v[170:171], v236 offset:57856
    s_add_u32 m0, s67, 0xc000
    s_add_u32 s41, s40, 6
    s_and_b32 s41, s41, 7
    s_mul_i32 s52, s41, 0x38000
    buffer_load_dwordx4 v242, s[16:19], s52 offen lds
    v_and_b32 v230, s59, v231
    v_mov_b32 v235, 0
    v_sub_f32 v230, v231, v230
    v_perm_b32 v232, v230, v231, s63
    v_mfma_f32_16x16x32_bf16 v[188:191], v[200:203], v[176:179], v[188:191]
    s_waitcnt lgkmcnt(5)
    v_mfma_f32_32x32x16_bf16 v[132:147], v[120:123], v[212:215], v[132:147]
    ds_read_b128 v[128:131], v195 offset:32768
    ds_read_b64_tr_b16 v[172:173], v237 offset:49152
    ds_read_b64_tr_b16 v[174:175], v237 offset:49664
    v_and_b32 v229, s59, v230
    v_sub_f32 v229, v230, v229
    v_lshrrev_b32 v233, 16, v229
    v_mfma_f32_32x32x16_bf16 v[148:163], v[216:219], v[120:123], v[148:163]
    ds_read_b64_tr_b16 v[176:177], v237 offset:57344
    ds_read_b64_tr_b16 v[178:179], v237 offset:57856
    s_add_u32 m0, s67, 0xe000
    s_add_u32 s41, s40, 7
    s_and_b32 s41, s41, 7
    s_mul_i32 s52, s41, 0x38000
    buffer_load_dwordx4 v242, s[16:19], s52 offen lds
    s_lshl_b32 s50, s42, 9
    s_add_u32 s50, s50, 155648
    v_add_u32 v246, s50, v255
    ds_write2st64_b32 v246, v196, v188 offset0:0 offset1:1
    s_lshl_b32 s50, s44, 11
    s_add_u32 s50, s50, 155648
    v_add_u32 v247, s50, v255
    s_waitcnt lgkmcnt(6)
    v_mfma_f32_32x32x16_bf16 v[132:147], v[124:127], v[164:167], v[132:147]
    v_mfma_f32_32x32x16_bf16 v[148:163], v[168:171], v[124:127], v[148:163]
    s_waitcnt lgkmcnt(0)
    s_barrier
    ds_read2st64_b32 v[220:221], v247 offset0:0 offset1:1
    ds_read2st64_b32 v[222:223], v247 offset0:2 offset1:3
    ds_read2st64_b32 v[224:225], v247 offset0:4 offset1:5
    ds_read2st64_b32 v[226:227], v247 offset0:6 offset1:7
    v_mfma_f32_32x32x16_bf16 v[132:147], v[128:131], v[172:175], v[132:147]
    v_mfma_f32_32x32x16_bf16 v[148:163], v[176:179], v[128:131], v[148:163]
    s_waitcnt lgkmcnt(0)
    v_add_f32 v220, v220, v222
    v_add_f32 v224, v224, v226
    v_add_f32 v221, v221, v223
    v_add_f32 v225, v225, v227
    v_add_f32 v246, v220, v224
    v_add_f32 v247, v221, v225
    v_mov_b32 v164, 0x3f803f80
    v_mov_b32 v165, 0x3f803f80
    v_mov_b32 v166, 0
    v_mov_b32 v167, 0
    s_nop 1
    v_mfma_f32_32x32x16_bf16 v[216:231], v[232:235], v[164:167], 0
    v_perm_b32 v208, v246, v246, s62
    v_and_b32 v211, s59, v246
    v_sub_f32 v211, v246, v211
    v_perm_b32 v209, v211, v211, s62
    v_mov_b32 v210, 0
    v_mov_b32 v211, 0
    s_nop 1
    v_mfma_f32_32x32x16_bf16 v[132:147], v[204:207], v[208:211], v[132:147]
    v_perm_b32 v208, v247, v247, s62
    v_and_b32 v211, s59, v247
    v_sub_f32 v211, v247, v211
    v_perm_b32 v209, v211, v211, s62
    v_perm_b32 v210, v249, v249, s64
    v_mov_b32 v211, 0
    s_nop 1
    v_mfma_f32_32x32x16_bf16 v[148:163], v[208:211], v[204:207], v[148:163]
    s_nop 2
    v_mul_f32 v132, v132, v216
    v_mul_f32 v133, v133, v217
    v_mul_f32 v134, v134, v218
    v_mul_f32 v135, v135, v219
    v_mul_f32 v136, v136, v220
    v_mul_f32 v137, v137, v221
    v_mul_f32 v138, v138, v222
    v_mul_f32 v139, v139, v223
    v_cvt_pk_bf16_f32 v212, v132, v133
    v_cvt_pk_bf16_f32 v213, v134, v135
    v_cvt_pk_bf16_f32 v214, v136, v137
    v_cvt_pk_bf16_f32 v215, v138, v139
    buffer_store_dwordx4 v[212:215], v238, s[36:39], s60 offen offset:0 sc1
    v_mul_f32 v140, v140, v224
    v_mul_f32 v141, v141, v225
    v_mul_f32 v142, v142, v226
    v_mul_f32 v143, v143, v227
    v_mul_f32 v144, v144, v228
    v_mul_f32 v145, v145, v229
    v_mul_f32 v146, v146, v230
    v_mul_f32 v147, v147, v231
    v_cvt_pk_bf16_f32 v232, v140, v141
    v_cvt_pk_bf16_f32 v233, v142, v143
    v_cvt_pk_bf16_f32 v234, v144, v145
    v_cvt_pk_bf16_f32 v235, v146, v147
    buffer_store_dwordx4 v[232:235], v238, s[36:39], s60 offen offset:512 sc1
    v_mul_f32 v216, v148, v148
    s_waitcnt vmcnt(6)
    s_barrier
    v_add_u32 v2, 0xffff0000, v2
    v_add_u32 v3, 0xffff0000, v3
    v_add_u32 v236, 0xffff0000, v236
    v_add_u32 v237, 0xffff0000, v237
    ds_read_b64_tr_b16 v[164:165], v2 offset:0
    ds_read_b64_tr_b16 v[166:167], v2 offset:512
    ds_read_b64_tr_b16 v[172:173], v2 offset:8192
    ds_read_b64_tr_b16 v[174:175], v2 offset:8704
    s_waitcnt lgkmcnt(2)
    v_mfma_f32_32x32x16_bf16 v[180:195], v[164:167], v[4:7], 0
    ds_read_b64_tr_b16 v[168:169], v2 offset:16384
    ds_read_b64_tr_b16 v[170:171], v2 offset:16896
    v_mul_f32 v217, v149, v149
    v_mul_f32 v218, v150, v150
    v_mul_f32 v219, v151, v151
    v_mul_f32 v220, v152, v152
    v_mul_f32 v221, v153, v153
    v_mul_f32 v222, v154, v154
    v_mfma_f32_16x16x32_bf16 v[196:199], v[200:203], v[164:167], 0
    s_waitcnt lgkmcnt(2)
    v_mfma_f32_32x32x16_bf16 v[180:195], v[172:175], v[20:23], v[180:195]
    ds_read_b64_tr_b16 v[176:177], v2 offset:24576
    ds_read_b64_tr_b16 v[178:179], v2 offset:25088
    v_mul_f32 v223, v155, v155
    v_fma_f32 v216, v216, v250, v248
    v_fma_f32 v217, v217, v250, v248
    v_fma_f32 v218, v218, v250, v248
    v_fma_f32 v219, v219, v250, v248
    v_fma_f32 v220, v220, v250, v248
    v_mfma_f32_16x16x32_bf16 v[196:199], v[200:203], v[172:175], v[196:199]
    s_waitcnt lgkmcnt(2)
    v_mfma_f32_32x32x16_bf16 v[180:195], v[168:171], v[36:39], v[180:195]
    ds_read_b64_tr_b16 v[164:165], v3 offset:0
    ds_read_b64_tr_b16 v[166:167], v3 offset:512
    v_fma_f32 v221, v221, v250, v248
    v_fma_f32 v222, v222, v250, v248
    v_fma_f32 v223, v223, v250, v248
    v_mul_f32 v216, v216, v148
    v_mul_f32 v217, v217, v149
    v_mul_f32 v218, v218, v150
    v_mfma_f32_16x16x32_bf16 v[196:199], v[200:203], v[168:171], v[196:199]
    s_waitcnt lgkmcnt(2)
    v_mfma_f32_32x32x16_bf16 v[180:195], v[176:179], v[52:55], v[180:195]
    ds_read_b64_tr_b16 v[172:173], v236 offset:0
    ds_read_b64_tr_b16 v[174:175], v236 offset:512
    v_mul_f32 v219, v219, v151
    v_mul_f32 v220, v220, v152
    v_mul_f32 v221, v221, v153
    v_mul_f32 v222, v222, v154
    v_mul_f32 v223, v223, v155
    v_exp_f32 v216, v216
    v_mfma_f32_16x16x32_bf16 v[196:199], v[200:203], v[176:179], v[196:199]
    s_waitcnt lgkmcnt(2)
    v_mfma_f32_32x32x16_bf16 v[180:195], v[164:167], v[8:11], v[180:195]
    ds_read_b64_tr_b16 v[168:169], v237 offset:0
    ds_read_b64_tr_b16 v[170:171], v237 offset:512
    v_exp_f32 v217, v217
    v_exp_f32 v218, v218
    v_exp_f32 v219, v219
    s_waitcnt lgkmcnt(2)
    v_mfma_f32_32x32x16_bf16 v[180:195], v[172:175], v[12:15], v[180:195]
    ds_read_b64_tr_b16 v[176:177], v3 offset:8192
    ds_read_b64_tr_b16 v[178:179], v3 offset:8704
    v_exp_f32 v220, v220
    v_exp_f32 v221, v221
    v_exp_f32 v222, v222
    s_waitcnt vmcnt(0)
    v_mov_b32 v246, 151552
    v_mov_b32 v247, 1
    s_mov_b64 exec, 1
    ds_add_rtn_u32 v247, v246, v247
    s_mov_b64 exec, -1
    s_waitcnt lgkmcnt(3)
    v_mfma_f32_32x32x16_bf16 v[180:195], v[168:171], v[16:19], v[180:195]
    ds_read_b64_tr_b16 v[164:165], v236 offset:8192
    ds_read_b64_tr_b16 v[166:167], v236 offset:8704
    v_exp_f32 v223, v223
    v_fma_f32 v216, v216, v252, v252
    v_fma_f32 v217, v217, v252, v252
    v_fma_f32 v218, v218, v252, v252
    v_fma_f32 v219, v219, v252, v252
    s_waitcnt lgkmcnt(3)
    v_mfma_f32_32x32x16_bf16 v[180:195], v[176:179], v[24:27], v[180:195]
    ds_read_b64_tr_b16 v[172:173], v237 offset:8192
    ds_read_b64_tr_b16 v[174:175], v237 offset:8704
    v_fma_f32 v220, v220, v252, v252
    v_fma_f32 v221, v221, v252, v252
    v_fma_f32 v222, v222, v252, v252
    v_fma_f32 v223, v223, v252, v252
    v_rcp_f32 v216, v216
    s_waitcnt lgkmcnt(4)
    v_readfirstlane_b32 s50, v247
    s_lshl_b32 s51, s48, 12
    s_lshl_b32 s53, s47, 8
    s_add_u32 s51, s51, s53
    s_add_u32 s51, s51, 0x1810080
    s_cmp_lg_u32 s50, 7
    s_cbranch_scc1 L_sig_22
    v_mov_b32 v246, s78
    s_mov_b64 exec, 1
    buffer_store_dword v246, off, s[36:39], s51 sc1
    s_mov_b64 exec, -1
L_sig_22:
    s_waitcnt lgkmcnt(2)
    v_mfma_f32_32x32x16_bf16 v[180:195], v[164:167], v[28:31], v[180:195]
    ds_read_b64_tr_b16 v[168:169], v3 offset:16384
    ds_read_b64_tr_b16 v[170:171], v3 offset:16896
    v_rcp_f32 v217, v217
    v_rcp_f32 v218, v218
    v_rcp_f32 v219, v219
    s_waitcnt lgkmcnt(2)
    v_mfma_f32_32x32x16_bf16 v[180:195], v[172:175], v[32:35], v[180:195]
    ds_read_b64_tr_b16 v[176:177], v236 offset:16384
    ds_read_b64_tr_b16 v[178:179], v236 offset:16896
    v_rcp_f32 v220, v220
    v_rcp_f32 v221, v221
    v_rcp_f32 v222, v222
    s_waitcnt lgkmcnt(2)
    v_mfma_f32_32x32x16_bf16 v[180:195], v[168:171], v[40:43], v[180:195]
    ds_read_b64_tr_b16 v[164:165], v237 offset:16384
    ds_read_b64_tr_b16 v[166:167], v237 offset:16896
    v_rcp_f32 v223, v223
    v_mul_f32 v216, v216, v148
    v_mul_f32 v217, v217, v149
    v_mul_f32 v218, v218, v150
    v_mul_f32 v219, v219, v151
    s_and_b32 s50, s2, 63
    s_lshr_b32 s51, s2, 7
    s_lshl_b32 s51, s51, 6
    s_add_u32 s50, s50, s51
    s_add_u32 s53, s50, 1024
    s_lshl_b32 s50, s50, 3
    s_lshl_b32 s51, s43, 1
    s_add_u32 s77, s50, s51
    s_lshl_b32 s82, s42, 12
    s_add_u32 s82, s82, 131072
    s_cmp_eq_u32 s42, 5
    s_cselect_b32 s77, s53, s77
    s_cselect_b32 s82, 153600, s82
    s_cselect_b32 s50, 0, s44
    s_cmp_lg_u32 s50, 0
    s_cbranch_scc1 L_rl_23
    s_cmp_ge_u32 s77, 896
    s_cselect_b32 s20, s12, s24
    s_cselect_b32 s21, s13, s25
    s_cselect_b32 s22, s14, s26
    s_cselect_b32 s50, 896, 0
    s_sub_u32 s50, s77, s50
    s_and_b32 s51, s50, 7
    s_lshl_b32 s51, s51, 7
    s_lshr_b32 s50, s50, 3
    s_lshl_b32 s50, s50, 14
    s_add_u32 s50, s50, s51
    v_lshrrev_b32 v240, 3, v0
    v_and_b32 v241, 7, v0
    v_bfe_u32 v239, v0, 4, 1
    v_lshlrev_b32 v239, 2, v239
    v_xor_b32 v241, v241, v239
    v_lshlrev_b32 v241, 4, v241
    v_lshl_add_u32 v240, v240, 10, v241
    v_add_u32 v241, 7168, v240
    s_add_u32 m0, s82, 0
    s_nop 0
    buffer_load_dwordx4 v240, s[20:23], s50 offen lds
    buffer_load_dwordx4 v241, s[20:23], s50 offen offset:1024 lds
    s_cmp_eq_u32 s42, 5
    s_cbranch_scc1 L_rl_23
    s_add_u32 s50, s50, 128
    s_add_u32 m0, s82, 2048
    s_nop 0
    buffer_load_dwordx4 v240, s[20:23], s50 offen lds
    buffer_load_dwordx4 v241, s[20:23], s50 offen offset:1024 lds
L_rl_23:
    s_waitcnt lgkmcnt(2)
    v_mfma_f32_32x32x16_bf16 v[180:195], v[176:179], v[44:47], v[180:195]
    ds_read_b64_tr_b16 v[172:173], v3 offset:24576
    ds_read_b64_tr_b16 v[174:175], v3 offset:25088
    v_mul_f32 v220, v220, v152
    v_mul_f32 v221, v221, v153
    v_mul_f32 v222, v222, v154
    v_mul_f32 v223, v223, v155
    v_cvt_pk_bf16_f32 v148, v216, v217
    v_cvt_pk_bf16_f32 v149, v218, v219
    s_waitcnt lgkmcnt(2)
    v_mfma_f32_32x32x16_bf16 v[180:195], v[164:167], v[48:51], v[180:195]
    ds_read_b64_tr_b16 v[168:169], v236 offset:24576
    ds_read_b64_tr_b16 v[170:171], v236 offset:25088
    v_cvt_pk_bf16_f32 v150, v220, v221
    v_cvt_pk_bf16_f32 v151, v222, v223
    v_mul_f32 v224, v156, v156
    v_mul_f32 v225, v157, v157
    v_mul_f32 v226, v158, v158
    v_mul_f32 v227, v159, v159
    s_waitcnt lgkmcnt(2)
    v_mfma_f32_32x32x16_bf16 v[180:195], v[172:175], v[56:59], v[180:195]
    ds_read_b64_tr_b16 v[176:177], v237 offset:24576
    ds_read_b64_tr_b16 v[178:179], v237 offset:25088
    v_mul_f32 v228, v160, v160
    v_mul_f32 v229, v161, v161
    v_mul_f32 v230, v162, v162
    v_mul_f32 v231, v163, v163
    v_fma_f32 v224, v224, v250, v248
    v_fma_f32 v225, v225, v250, v248
    s_barrier
    s_waitcnt lgkmcnt(2)
    v_mfma_f32_32x32x16_bf16 v[180:195], v[168:171], v[60:63], v[180:195]
    ds_read_b64_tr_b16 v[164:165], v2 offset:32768
    ds_read_b64_tr_b16 v[166:167], v2 offset:33280
    v_fma_f32 v226, v226, v250, v248
    v_fma_f32 v227, v227, v250, v248
    v_fma_f32 v228, v228, v250, v248
    v_fma_f32 v229, v229, v250, v248
    v_fma_f32 v230, v230, v250, v248
    v_fma_f32 v231, v231, v250, v248
    s_waitcnt lgkmcnt(2)
    v_mfma_f32_32x32x16_bf16 v[180:195], v[176:179], v[64:67], v[180:195]
    ds_read_b64_tr_b16 v[172:173], v2 offset:40960
    ds_read_b64_tr_b16 v[174:175], v2 offset:41472
    v_mul_f32 v224, v224, v156
    v_mul_f32 v225, v225, v157
    v_mul_f32 v226, v226, v158
    v_mul_f32 v227, v227, v159
    v_mul_f32 v228, v228, v160
    v_mul_f32 v229, v229, v161
    s_waitcnt lgkmcnt(2)
    v_mfma_f32_32x32x16_bf16 v[180:195], v[164:167], v[68:71], v[180:195]
    ds_read_b64_tr_b16 v[168:169], v2 offset:49152
    ds_read_b64_tr_b16 v[170:171], v2 offset:49664
    v_mul_f32 v230, v230, v162
    v_mul_f32 v231, v231, v163
    v_exp_f32 v224, v224
    v_exp_f32 v225, v225
    v_mfma_f32_16x16x32_bf16 v[196:199], v[200:203], v[164:167], v[196:199]
    s_waitcnt lgkmcnt(2)
    v_mfma_f32_32x32x16_bf16 v[180:195], v[172:175], v[84:87], v[180:195]
    ds_read_b64_tr_b16 v[176:177], v2 offset:57344
    ds_read_b64_tr_b16 v[178:179], v2 offset:57856
    v_exp_f32 v226, v226
    v_exp_f32 v227, v227
    v_exp_f32 v228, v228
    v_mfma_f32_16x16x32_bf16 v[196:199], v[200:203], v[172:175], v[196:199]
    s_waitcnt lgkmcnt(2)
    v_mfma_f32_32x32x16_bf16 v[180:195], v[168:171], v[100:103], v[180:195]
    ds_read_b64_tr_b16 v[164:165], v3 offset:32768
    ds_read_b64_tr_b16 v[166:167], v3 offset:33280
    v_exp_f32 v229, v229
    v_exp_f32 v230, v230
    v_exp_f32 v231, v231
    v_mfma_f32_16x16x32_bf16 v[196:199], v[200:203], v[168:171], v[196:199]
    v_mov_b32 v132, -1
    v_mov_b32 v133, -1
    v_mov_b32 v134, -1
    v_mov_b32 v135, -1
    s_lshl_b32 s83, s69, 3
    s_add_u32 s83, s83, s42
    s_lshl_b32 s83, s83, 3
    s_add_u32 s83, s83, s45
    s_lshl_b32 s83, s83, 2
    s_lshr_b32 s50, s46, 3
    s_add_u32 s83, s83, s50
    s_lshl_b32 s83, s83, 10
    s_add_u32 s83, s83, 0x600000
    buffer_store_dwordx4 v[132:135], v254, s[36:39], s83 offen sc1
    s_waitcnt lgkmcnt(2)
    v_mfma_f32_32x32x16_bf16 v[180:195], v[176:179], v[116:119], v[180:195]
    ds_read_b64_tr_b16 v[172:173], v236 offset:32768
    ds_read_b64_tr_b16 v[174:175], v236 offset:33280
    v_fma_f32 v224, v224, v252, v252
    v_fma_f32 v225, v225, v252, v252
    v_fma_f32 v226, v226, v252, v252
    v_fma_f32 v227, v227, v252, v252
    v_fma_f32 v228, v228, v252, v252
    v_fma_f32 v229, v229, v252, v252
    v_mfma_f32_16x16x32_bf16 v[196:199], v[200:203], v[176:179], v[196:199]
    s_waitcnt lgkmcnt(2)
    v_mfma_f32_32x32x16_bf16 v[180:195], v[164:167], v[72:75], v[180:195]
    ds_read_b64_tr_b16 v[168:169], v237 offset:32768
    ds_read_b64_tr_b16 v[170:171], v237 offset:33280
    v_fma_f32 v230, v230, v252, v252
    v_fma_f32 v231, v231, v252, v252
    v_rcp_f32 v224, v224
    v_rcp_f32 v225, v225
    s_waitcnt lgkmcnt(2)
    v_mfma_f32_32x32x16_bf16 v[180:195], v[172:175], v[76:79], v[180:195]
    ds_read_b64_tr_b16 v[176:177], v3 offset:40960
    ds_read_b64_tr_b16 v[178:179], v3 offset:41472
    v_rcp_f32 v226, v226
    v_rcp_f32 v227, v227
    v_rcp_f32 v228, v228
    s_lshl_b32 s50, s42, 8
    s_add_u32 s50, s50, 0x24000
    v_add_u32 v242, s50, v255
    ds_write_b32 v242, v196
    s_lshl_b32 s50, s44, 10
    s_add_u32 s50, s50, 0x24000
    v_add_u32 v242, s50, v255
    s_waitcnt lgkmcnt(3)
    v_mfma_f32_32x32x16_bf16 v[180:195], v[168:171], v[80:83], v[180:195]
    ds_read_b64_tr_b16 v[164:165], v236 offset:40960
    ds_read_b64_tr_b16 v[166:167], v236 offset:41472
    v_rcp_f32 v229, v229
    v_rcp_f32 v230, v230
    v_rcp_f32 v231, v231
    s_waitcnt lgkmcnt(3)
    v_mfma_f32_32x32x16_bf16 v[180:195], v[176:179], v[88:91], v[180:195]
    ds_read_b64_tr_b16 v[172:173], v237 offset:40960
    ds_read_b64_tr_b16 v[174:175], v237 offset:41472
    v_mul_f32 v224, v224, v156
    v_mul_f32 v225, v225, v157
    v_mul_f32 v226, v226, v158
    v_mul_f32 v227, v227, v159
    v_mul_f32 v228, v228, v160
    v_mul_f32 v229, v229, v161
    s_waitcnt lgkmcnt(4)
    s_barrier
    ds_read2st64_b32 v[196:197], v242 offset0:0 offset1:1
    ds_read2st64_b32 v[198:199], v242 offset0:2 offset1:3
    s_waitcnt lgkmcnt(4)
    v_mfma_f32_32x32x16_bf16 v[180:195], v[164:167], v[92:95], v[180:195]
    ds_read_b64_tr_b16 v[168:169], v3 offset:49152
    ds_read_b64_tr_b16 v[170:171], v3 offset:49664
    v_mul_f32 v230, v230, v162
    v_mul_f32 v231, v231, v163
    v_cvt_pk_bf16_f32 v156, v224, v225
    v_cvt_pk_bf16_f32 v157, v226, v227
    v_cvt_pk_bf16_f32 v158, v228, v229
    v_cvt_pk_bf16_f32 v159, v230, v231
    s_lshl_b32 s81, s45, 12
    s_add_u32 s81, s81, 0x1810000
    s_cmp_lg_u32 s42, 4
    s_cbranch_scc1 L_li_24
    v_and_b32 v241, 31, v0
    v_lshlrev_b32 v241, 7, v241
    buffer_load_dword v240, v241, s[36:39], s81 offen sc1
L_li_24:
    s_waitcnt lgkmcnt(4)
    v_mfma_f32_32x32x16_bf16 v[180:195], v[172:175], v[96:99], v[180:195]
    ds_read_b64_tr_b16 v[176:177], v236 offset:49152
    ds_read_b64_tr_b16 v[178:179], v236 offset:49664
    s_waitcnt lgkmcnt(2)
    v_mfma_f32_32x32x16_bf16 v[180:195], v[168:171], v[104:107], v[180:195]
    ds_read_b64_tr_b16 v[164:165], v237 offset:49152
    ds_read_b64_tr_b16 v[166:167], v237 offset:49664
    v_add_f32 v196, v196, v197
    v_add_f32 v198, v198, v199
    v_add_f32 v196, v196, v198
    v_perm_b32 v208, v196, v196, s62
    v_and_b32 v211, s59, v196
    v_sub_f32 v211, v196, v211
    v_perm_b32 v209, v211, v211, s62
    v_perm_b32 v210, v251, v251, s64
    v_mov_b32 v211, 0
    s_waitcnt lgkmcnt(2)
    v_mfma_f32_32x32x16_bf16 v[180:195], v[176:179], v[108:111], v[180:195]
    ds_read_b64_tr_b16 v[172:173], v3 offset:57344
    ds_read_b64_tr_b16 v[174:175], v3 offset:57856
    v_mfma_f32_32x32x16_bf16 v[180:195], v[208:211], v[204:207], v[180:195]
    s_waitcnt lgkmcnt(2)
    v_mfma_f32_32x32x16_bf16 v[180:195], v[164:167], v[112:115], v[180:195]
    ds_read_b64_tr_b16 v[168:169], v236 offset:57344
    ds_read_b64_tr_b16 v[170:171], v236 offset:57856
    s_waitcnt lgkmcnt(2)
    v_mfma_f32_32x32x16_bf16 v[180:195], v[172:175], v[120:123], v[180:195]
    ds_read_b64_tr_b16 v[176:177], v237 offset:57344
    ds_read_b64_tr_b16 v[178:179], v237 offset:57856
    s_waitcnt lgkmcnt(2)
    v_mfma_f32_32x32x16_bf16 v[180:195], v[168:171], v[124:127], v[180:195]
    s_waitcnt lgkmcnt(0)
    v_mfma_f32_32x32x16_bf16 v[180:195], v[176:179], v[128:131], v[180:195]
    s_cmp_lg_u32 s42, 4
    s_cbranch_scc1 L_np1b_25
    s_waitcnt vmcnt(0)
    v_cmp_ne_u32 vcc, s78, v240
    v_mov_b32 v246, 151556
    s_cmp_eq_u64 vcc, 0
    s_cselect_b32 s50, 1, 0
    v_mov_b32 v247, s50
    ds_write_b32 v246, v247
    s_cbranch_scc1 L_np1b_25
    buffer_load_dword v240, v241, s[36:39], s81 offen sc1
L_np1b_25:
    s_mov_b32 s56, 0
    v_mov_b32 v239, 151556
    s_waitcnt lgkmcnt(0)
    s_barrier
    ds_read_b32 v239, v239
    s_mov_b32 s57, 0
    s_waitcnt lgkmcnt(0)
    s_cmp_lg_u32 s56, 0
    s_cbranch_scc1 L_te_26
    v_readfirstlane_b32 s50, v239
    s_nop 0
    s_cmp_eq_u32 s50, 0
    s_cbranch_scc1 L_te_26
    s_mov_b32 s56, 1
    s_mov_b32 s51, s67
    s_lshl_b32 s80, s68, 16
    s_add_u32 s80, s80, s51
    s_add_u32 m0, s51, 0
    s_add_u32 s52, s80, 0x200000
    buffer_load_dwordx4 v254, s[36:39], s52 offen sc1 lds
    s_add_u32 m0, s51, 155648
    s_lshl_b32 s52, s69, 13
    s_add_u32 s52, s52, s80
    buffer_load_dwordx4 v254, s[36:39], s52 offen sc1 lds
    s_add_u32 m0, s51, 98304
    s_add_u32 s52, s80, 0x400000
    buffer_load_dwordx4 v254, s[36:39], s52 offen sc1 lds
    s_add_u32 m0, s51, 8192
    s_add_u32 s52, s80, 0x202000
    buffer_load_dwordx4 v254, s[36:39], s52 offen sc1 lds
    s_add_u32 m0, s51, 106496
    s_add_u32 s52, s80, 0x402000
    buffer_load_dwordx4 v254, s[36:39], s52 offen sc1 lds
L_te_26:
    s_nop 0
    v_pk_mul_f32 v[216:217], v[180:181], v[180:181]
    v_pk_mul_f32 v[218:219], v[182:183], v[182:183]
    v_pk_mul_f32 v[220:221], v[184:185], v[184:185]
    v_pk_mul_f32 v[222:223], v[186:187], v[186:187]
    v_pk_fma_f32 v[216:217], v[216:217], v[250:251], v[248:249] op_sel_hi:[1,0,0]
    v_pk_fma_f32 v[218:219], v[218:219], v[250:251], v[248:249] op_sel_hi:[1,0,0]
    v_pk_fma_f32 v[220:221], v[220:221], v[250:251], v[248:249] op_sel_hi:[1,0,0]
    v_pk_fma_f32 v[222:223], v[222:223], v[250:251], v[248:249] op_sel_hi:[1,0,0]
    v_pk_mul_f32 v[216:217], v[216:217], v[180:181]
    v_pk_mul_f32 v[218:219], v[218:219], v[182:183]
    v_pk_mul_f32 v[220:221], v[220:221], v[184:185]
    v_pk_mul_f32 v[222:223], v[222:223], v[186:187]
    v_exp_f32 v216, v216
    v_exp_f32 v217, v217
    v_exp_f32 v218, v218
    v_exp_f32 v219, v219
    v_exp_f32 v220, v220
    v_exp_f32 v221, v221
    v_exp_f32 v222, v222
    v_exp_f32 v223, v223
    v_pk_fma_f32 v[216:217], v[216:217], v[252:253], v[252:253] op_sel_hi:[1,0,0]
    v_pk_fma_f32 v[218:219], v[218:219], v[252:253], v[252:253] op_sel_hi:[1,0,0]
    v_pk_fma_f32 v[220:221], v[220:221], v[252:253], v[252:253] op_sel_hi:[1,0,0]
    v_pk_fma_f32 v[222:223], v[222:223], v[252:253], v[252:253] op_sel_hi:[1,0,0]
    v_rcp_f32 v216, v216
    v_rcp_f32 v217, v217
    v_rcp_f32 v218, v218
    v_rcp_f32 v219, v219
    v_rcp_f32 v220, v220
    v_rcp_f32 v221, v221
    v_rcp_f32 v222, v222
    v_rcp_f32 v223, v223
    v_pk_mul_f32 v[216:217], v[216:217], v[180:181]
    v_pk_mul_f32 v[218:219], v[218:219], v[182:183]
    v_pk_mul_f32 v[220:221], v[220:221], v[184:185]
    v_pk_mul_f32 v[222:223], v[222:223], v[186:187]
    v_cvt_pk_bf16_f32 v180, v216, v217
    v_cvt_pk_bf16_f32 v181, v218, v219
    v_cvt_pk_bf16_f32 v182, v220, v221
    v_cvt_pk_bf16_f32 v183, v222, v223
    s_cmp_eq_u32 s56, 0
    s_cbranch_scc1 L_hs_28
    s_bitcmp1_b32 s57, 0
    s_cbranch_scc1 L_hs_28
    buffer_store_dwordx4 v[148:151], v254, s[36:39], s74 offen offset:0 sc1
    buffer_store_dwordx4 v[156:159], v254, s[36:39], s74 offen offset:1024 sc1
    s_bitset1_b32 s57, 0
L_hs_28:
    s_cmp_eq_u32 s56, 0
    s_cbranch_scc1 L_hs_29
    s_bitcmp1_b32 s57, 1
    s_cbranch_scc1 L_hs_29
    buffer_store_dwordx4 v[180:183], v254, s[36:39], s75 offen offset:0 sc1
    s_bitset1_b32 s57, 1
L_hs_29:
    s_cmp_lg_u32 s56, 0
    s_cbranch_scc1 L_lw_30
    s_cmp_lg_u32 s42, 4
    s_cbranch_scc1 L_lw_30
    s_mov_b32 s79, 0x40000
L_poll_31:
    s_waitcnt vmcnt(0)
    v_cmp_ne_u32 vcc, s78, v240
    s_nop 0
    s_cbranch_vccz L_polld_32
    buffer_load_dword v240, v241, s[36:39], s81 offen sc1
    s_sub_u32 s79, s79, 1
    s_cmp_lg_u32 s79, 0
    s_cbranch_scc1 L_poll_31
    s_waitcnt vmcnt(0)
L_polld_32:
    v_mov_b32 v240, 151556
    v_mov_b32 v241, 1
    ds_write_b32 v240, v241
    s_mov_b32 s56, 1
    s_mov_b32 s51, s67
    s_lshl_b32 s80, s68, 16
    s_add_u32 s80, s80, s51
    s_add_u32 m0, s51, 0
    s_add_u32 s52, s80, 0x200000
    buffer_load_dwordx4 v254, s[36:39], s52 offen sc1 lds
    s_add_u32 m0, s51, 155648
    s_lshl_b32 s52, s69, 13
    s_add_u32 s52, s52, s80
    buffer_load_dwordx4 v254, s[36:39], s52 offen sc1 lds
    s_add_u32 m0, s51, 98304
    s_add_u32 s52, s80, 0x400000
    buffer_load_dwordx4 v254, s[36:39], s52 offen sc1 lds
    s_add_u32 m0, s51, 8192
    s_add_u32 s52, s80, 0x202000
    buffer_load_dwordx4 v254, s[36:39], s52 offen sc1 lds
    s_add_u32 m0, s51, 106496
    s_add_u32 s52, s80, 0x402000
    buffer_load_dwordx4 v254, s[36:39], s52 offen sc1 lds
L_lw_30:
    v_mov_b32 v239, 151556
    ds_read_b32 v239, v239
    v_pk_mul_f32 v[224:225], v[188:189], v[188:189]
    v_pk_mul_f32 v[226:227], v[190:191], v[190:191]
    v_pk_mul_f32 v[228:229], v[192:193], v[192:193]
    v_pk_mul_f32 v[230:231], v[194:195], v[194:195]
    v_pk_fma_f32 v[224:225], v[224:225], v[250:251], v[248:249] op_sel_hi:[1,0,0]
    v_pk_fma_f32 v[226:227], v[226:227], v[250:251], v[248:249] op_sel_hi:[1,0,0]
    v_pk_fma_f32 v[228:229], v[228:229], v[250:251], v[248:249] op_sel_hi:[1,0,0]
    v_pk_fma_f32 v[230:231], v[230:231], v[250:251], v[248:249] op_sel_hi:[1,0,0]
    v_pk_mul_f32 v[224:225], v[224:225], v[188:189]
    v_pk_mul_f32 v[226:227], v[226:227], v[190:191]
    v_pk_mul_f32 v[228:229], v[228:229], v[192:193]
    v_pk_mul_f32 v[230:231], v[230:231], v[194:195]
    s_waitcnt lgkmcnt(0)
    s_cmp_lg_u32 s56, 0
    s_cbranch_scc1 L_te_33
    v_readfirstlane_b32 s50, v239
    s_nop 0
    s_cmp_eq_u32 s50, 0
    s_cbranch_scc1 L_te_33
    s_mov_b32 s56, 1
    s_mov_b32 s51, s67
    s_lshl_b32 s80, s68, 16
    s_add_u32 s80, s80, s51
    s_add_u32 m0, s51, 0
    s_add_u32 s52, s80, 0x200000
    buffer_load_dwordx4 v254, s[36:39], s52 offen sc1 lds
    s_add_u32 m0, s51, 155648
    s_lshl_b32 s52, s69, 13
    s_add_u32 s52, s52, s80
    buffer_load_dwordx4 v254, s[36:39], s52 offen sc1 lds
    s_add_u32 m0, s51, 98304
    s_add_u32 s52, s80, 0x400000
    buffer_load_dwordx4 v254, s[36:39], s52 offen sc1 lds
    s_add_u32 m0, s51, 8192
    s_add_u32 s52, s80, 0x202000
    buffer_load_dwordx4 v254, s[36:39], s52 offen sc1 lds
    s_add_u32 m0, s51, 106496
    s_add_u32 s52, s80, 0x402000
    buffer_load_dwordx4 v254, s[36:39], s52 offen sc1 lds
L_te_33:
    v_exp_f32 v224, v224
    v_exp_f32 v225, v225
    v_exp_f32 v226, v226
    v_exp_f32 v227, v227
    v_exp_f32 v228, v228
    v_exp_f32 v229, v229
    v_exp_f32 v230, v230
    v_exp_f32 v231, v231
    v_pk_fma_f32 v[224:225], v[224:225], v[252:253], v[252:253] op_sel_hi:[1,0,0]
    v_pk_fma_f32 v[226:227], v[226:227], v[252:253], v[252:253] op_sel_hi:[1,0,0]
    v_pk_fma_f32 v[228:229], v[228:229], v[252:253], v[252:253] op_sel_hi:[1,0,0]
    v_pk_fma_f32 v[230:231], v[230:231], v[252:253], v[252:253] op_sel_hi:[1,0,0]
    v_rcp_f32 v224, v224
    v_rcp_f32 v225, v225
    v_rcp_f32 v226, v226
    v_rcp_f32 v227, v227
    v_rcp_f32 v228, v228
    v_rcp_f32 v229, v229
    v_rcp_f32 v230, v230
    v_rcp_f32 v231, v231
    v_pk_mul_f32 v[224:225], v[224:225], v[188:189]
    v_pk_mul_f32 v[226:227], v[226:227], v[190:191]
    v_pk_mul_f32 v[228:229], v[228:229], v[192:193]
    v_pk_mul_f32 v[230:231], v[230:231], v[194:195]
    v_cvt_pk_bf16_f32 v188, v224, v225
    v_cvt_pk_bf16_f32 v189, v226, v227
    v_cvt_pk_bf16_f32 v190, v228, v229
    v_cvt_pk_bf16_f32 v191, v230, v231
    s_cmp_lg_u32 s56, 0
    s_cbranch_scc1 L_te_35
    s_mov_b32 s79, 0x800000
L_ts_36:
    v_mov_b32 v239, 151556
    ds_read_b32 v239, v239
    s_sub_u32 s79, s79, 1
    s_waitcnt lgkmcnt(0)
    v_readfirstlane_b32 s50, v239
    s_cmp_eq_u32 s79, 0
    s_cselect_b32 s50, 1, s50
    s_cmp_eq_u32 s50, 0
    s_cbranch_scc1 L_ts_36
    s_mov_b32 s56, 1
    s_mov_b32 s51, s67
    s_lshl_b32 s80, s68, 16
    s_add_u32 s80, s80, s51
    s_add_u32 m0, s51, 0
    s_add_u32 s52, s80, 0x200000
    buffer_load_dwordx4 v254, s[36:39], s52 offen sc1 lds
    s_add_u32 m0, s51, 155648
    s_lshl_b32 s52, s69, 13
    s_add_u32 s52, s52, s80
    buffer_load_dwordx4 v254, s[36:39], s52 offen sc1 lds
    s_add_u32 m0, s51, 98304
    s_add_u32 s52, s80, 0x400000
    buffer_load_dwordx4 v254, s[36:39], s52 offen sc1 lds
    s_add_u32 m0, s51, 8192
    s_add_u32 s52, s80, 0x202000
    buffer_load_dwordx4 v254, s[36:39], s52 offen sc1 lds
    s_add_u32 m0, s51, 106496
    s_add_u32 s52, s80, 0x402000
    buffer_load_dwordx4 v254, s[36:39], s52 offen sc1 lds
L_te_35:
    s_bitcmp1_b32 s57, 0
    s_cbranch_scc1 L_hs_37
    buffer_store_dwordx4 v[148:151], v254, s[36:39], s74 offen offset:0 sc1
    buffer_store_dwordx4 v[156:159], v254, s[36:39], s74 offen offset:1024 sc1
    s_bitset1_b32 s57, 0
L_hs_37:
    s_bitcmp1_b32 s57, 1
    s_cbranch_scc1 L_hs_38
    buffer_store_dwordx4 v[180:183], v254, s[36:39], s75 offen offset:0 sc1
    s_bitset1_b32 s57, 1
L_hs_38:
    buffer_store_dwordx4 v[188:191], v254, s[36:39], s75 offen offset:1024 sc1
    s_waitcnt vmcnt(4)
    s_cmp_eq_u32 s42, 5
    s_cselect_b32 s50, 0, s44
    s_cmp_lg_u32 s50, 0
    s_cbranch_scc1 L_rlf_39
    v_lshrrev_b32 v246, 5, v0
    v_bfe_u32 v247, v0, 2, 2
    v_lshl_add_u32 v246, v246, 2, v247
    v_lshrrev_b32 v247, 1, v247
    v_lshlrev_b32 v247, 6, v247
    v_lshl_add_u32 v246, v246, 7, v247
    v_bfe_u32 v247, v0, 4, 1
    v_lshl_add_u32 v246, v247, 5, v246
    v_and_b32 v247, 3, v0
    v_lshl_add_u32 v246, v247, 3, v246
    v_add_u32 v246, s82, v246
    v_xor_b32 v247, 64, v246
    s_lshl_b32 s50, s77, 11
    s_add_u32 s51, s50, 0x1040000
    s_add_u32 s50, s50, 0x1000000
    s_cmp_ge_u32 s77, 896
    s_cselect_b32 s50, s51, s50
    ds_read_b64_tr_b16 v[164:165], v246 offset:0
    ds_read_b64_tr_b16 v[166:167], v246 offset:1024
    ds_read_b64_tr_b16 v[168:169], v247 offset:0
    ds_read_b64_tr_b16 v[170:171], v247 offset:1024
    s_waitcnt lgkmcnt(0)
    buffer_store_dwordx4 v[164:167], v254, s[36:39], s50 offen offset:0 sc1
    buffer_store_dwordx4 v[168:171], v254, s[36:39], s50 offen offset:1024 sc1
    s_cmp_eq_u32 s42, 5
    s_cbranch_scc1 L_rlf_39
    ds_read_b64_tr_b16 v[172:173], v246 offset:2048
    ds_read_b64_tr_b16 v[174:175], v246 offset:3072
    ds_read_b64_tr_b16 v[176:177], v247 offset:2048
    ds_read_b64_tr_b16 v[178:179], v247 offset:3072
    s_waitcnt lgkmcnt(0)
    buffer_store_dwordx4 v[172:175], v254, s[36:39], s50 offen offset:2048 sc1
    buffer_store_dwordx4 v[176:179], v254, s[36:39], s50 offen offset:3072 sc1
L_rlf_39:
L_p1end_3:
    v_lshlrev_b32 v2, 4, v0
    v_add_u32 v220, s67, v2
    v_mov_b32 v244, 0
    v_mov_b32 v245, 0
    v_mov_b32 v246, 65536
    v_add_u32 v220, 155648, v220
    ds_write_b64 v246, v[244:245]
    v_add_u32 v3, 0, v2
    s_waitcnt lgkmcnt(0)
    s_barrier
    ds_read_b128 v[220:223], v220
    ds_read_b128 v[224:227], v3
    s_cmp_eq_u32 s44, 0
    s_cbranch_scc1 L_pr_40
    s_setprio 1
L_pr_40:
    v_mov_b32 v244, 0xff800000
    s_lshl_b32 s81, s68, 16
    s_add_u32 s81, s81, s67
    v_mov_b32 v249, 0xdddddddd
    v_and_b32 v236, 15, v0
    v_lshrrev_b32 v237, 5, v0
    v_and_b32 v239, 27, v0
    v_lshlrev_b32 v237, 8, v237
    v_cmp_eq_u32 vcc, 16, v239
    v_lshl_add_u32 v237, v236, 4, v237
    v_mov_b32 v238, 0x3f803f80
    v_add_u32 v248, 98304, v237
    s_mov_b32 s40, 0xffff
    s_mov_b32 s41, 0xffff
    v_cndmask_b32 v228, 0, v238, vcc
    v_cndmask_b32 v229, 0, v238, vcc
    v_cndmask_b32 v230, 0, v238, vcc
    v_cndmask_b32 v231, 0, v238, vcc
    v_cndmask_b32 v232, 0, v238, vcc
    v_cndmask_b32 v233, 0, v238, vcc
    v_cndmask_b32 v234, 0, v238, vcc
    v_cndmask_b32 v235, 0, v238, vcc
    v_mov_b32 v52, 0
    s_waitcnt lgkmcnt(0)
    v_mfma_f32_32x32x16_bf16 v[20:35], v[224:227], v[220:223], 0
    v_mov_b32 v53, 0
    v_mov_b32 v54, 0
    v_mov_b32 v55, 0
    v_mov_b32 v56, 0
    v_mov_b32 v57, 0
    v_mov_b32 v58, 0
    v_mov_b32 v59, 0
    v_mov_b32 v60, 0
    v_mov_b32 v61, 0
    v_mov_b32 v62, 0
    v_mov_b32 v63, 0
    v_mov_b32 v64, 0
    v_mov_b32 v65, 0
    v_mov_b32 v66, 0
    v_mov_b32 v67, 0
    v_max3_f32 v244, v20, v21, v244
    v_max3_f32 v244, v22, v23, v244
    v_max3_f32 v244, v24, v25, v244
    v_max3_f32 v244, v26, v27, v244
    v_max3_f32 v244, v28, v29, v244
    v_max3_f32 v244, v30, v31, v244
    v_max3_f32 v244, v32, v33, v244
    v_max3_f32 v244, v34, v35, v244
    v_mov_b32 v245, v244
    s_nop 1
    v_permlane32_swap_b32 v244, v245
    v_max_f32 v244, v244, v245
    v_sub_f32 v36, 0, v244
    v_mov_b32 v37, v36
    v_mov_b32 v38, v36
    v_mov_b32 v39, v36
    v_mov_b32 v40, v36
    v_mov_b32 v41, v36
    v_mov_b32 v42, v36
    v_mov_b32 v43, v36
    v_mov_b32 v44, v36
    v_mov_b32 v45, v36
    v_mov_b32 v46, v36
    v_mov_b32 v47, v36
    v_mov_b32 v48, v36
    v_mov_b32 v49, v36
    v_mov_b32 v50, v36
    v_mov_b32 v51, v36
    s_nop 1
    v_mfma_f32_32x32x16_bf16 v[4:19], v[224:227], v[220:223], v[36:51]
    ds_read_b128 v[224:227], v3 offset:1024
    s_mov_b64 exec, s[40:41]
    ds_read_b128 v[228:231], v248
    s_mov_b64 exec, -1
    v_lshrrev_b32 v236, 4, v0
    v_lshlrev_b32 v236, 10, v236
    v_and_b32 v237, 15, v0
    v_lshl_add_u32 v236, v237, 4, v236
    s_lshl_b32 s50, s70, 15
    s_lshl_b32 s51, s42, 12
    s_add_u32 s50, s50, s51
    s_lshl_b32 s51, s71, 8
    s_add_u32 s50, s50, s51
    v_add_u32 v250, s50, v236
    s_mul_i32 s72, s70, 114688
    s_mul_i32 s50, s42, 14336
    s_add_u32 s72, s72, s50
    s_add_u32 s72, s72, 0x800000
    s_mul_i32 s73, s42, 229376
    s_lshl_b32 s50, s71, 12
    s_add_u32 s73, s73, s50
    s_add_u32 s73, s73, 0x1000000
    s_lshl_b32 s74, s44, 18
    s_add_u32 s74, s74, s50
    s_lshl_b32 s50, s43, 10
    s_add_u32 s74, s74, s50
    s_add_u32 s74, s74, 0x1200000
    s_mov_b32 s58, 0x5f800000
    s_mov_b32 s59, 0x7b800000
    v_exp_f32 v4, v4
    v_exp_f32 v5, v5
    s_mov_b64 exec, s[40:41]
    ds_read_b128 v[232:235], v248 offset:512
    s_mov_b64 exec, -1
    v_exp_f32 v6, v6
    v_exp_f32 v7, v7
    v_exp_f32 v8, v8
    v_exp_f32 v9, v9
    s_waitcnt lgkmcnt(2)
    v_mfma_f32_32x32x16_bf16 v[20:35], v[224:227], v[220:223], v[36:51]
    ds_read_b128 v[224:227], v3 offset:2048
    v_exp_f32 v10, v10
    v_exp_f32 v11, v11
    v_exp_f32 v12, v12
    v_exp_f32 v13, v13
    s_waitcnt lgkmcnt(2)
    v_smfmac_f32_32x32x32_bf16 v[52:67], v[228:231], v[4:11], v249
    s_mov_b64 exec, s[40:41]
    ds_read_b128 v[228:231], v248 offset:1024
    s_mov_b64 exec, -1
    v_exp_f32 v14, v14
    v_exp_f32 v15, v15
    v_exp_f32 v16, v16
    v_exp_f32 v17, v17
    v_exp_f32 v18, v18
    v_exp_f32 v19, v19
    v_exp_f32 v20, v20
    v_exp_f32 v21, v21
    s_waitcnt lgkmcnt(2)
    v_smfmac_f32_32x32x32_bf16 v[52:67], v[232:235], v[12:19], v249
    s_mov_b64 exec, s[40:41]
    ds_read_b128 v[232:235], v248 offset:1536
    s_mov_b64 exec, -1
    v_exp_f32 v22, v22
    v_exp_f32 v23, v23
    v_exp_f32 v24, v24
    v_exp_f32 v25, v25
    s_waitcnt lgkmcnt(2)
    v_mfma_f32_32x32x16_bf16 v[4:19], v[224:227], v[220:223], v[36:51]
    ds_read_b128 v[224:227], v3 offset:3072
    v_exp_f32 v26, v26
    v_exp_f32 v27, v27
    v_exp_f32 v28, v28
    v_exp_f32 v29, v29
    s_waitcnt lgkmcnt(2)
    v_smfmac_f32_32x32x32_bf16 v[52:67], v[228:231], v[20:27], v249
    s_mov_b64 exec, s[40:41]
    ds_read_b128 v[228:231], v248 offset:2048
    s_mov_b64 exec, -1
    v_exp_f32 v30, v30
    v_exp_f32 v31, v31
    v_exp_f32 v32, v32
    v_exp_f32 v33, v33
    v_exp_f32 v34, v34
    v_exp_f32 v35, v35
    v_exp_f32 v4, v4
    v_exp_f32 v5, v5
    s_waitcnt lgkmcnt(2)
    v_smfmac_f32_32x32x32_bf16 v[52:67], v[232:235], v[28:35], v249
    s_mov_b64 exec, s[40:41]
    ds_read_b128 v[232:235], v248 offset:2560
    s_mov_b64 exec, -1
    v_exp_f32 v6, v6
    v_exp_f32 v7, v7
    v_exp_f32 v8, v8
    v_exp_f32 v9, v9
    s_waitcnt lgkmcnt(2)
    v_mfma_f32_32x32x16_bf16 v[20:35], v[224:227], v[220:223], v[36:51]
    ds_read_b128 v[224:227], v3 offset:4096
    v_exp_f32 v10, v10
    v_exp_f32 v11, v11
    v_exp_f32 v12, v12
    v_exp_f32 v13, v13
    s_waitcnt lgkmcnt(2)
    v_smfmac_f32_32x32x32_bf16 v[52:67], v[228:231], v[4:11], v249
    s_mov_b64 exec, s[40:41]
    ds_read_b128 v[228:231], v248 offset:3072
    s_mov_b64 exec, -1
    v_exp_f32 v14, v14
    v_exp_f32 v15, v15
    v_exp_f32 v16, v16
    v_exp_f32 v17, v17
    s_waitcnt vmcnt(0)
    v_mov_b32 v196, 65536
    v_mov_b32 v197, 1
    s_mov_b64 exec, 1
    ds_add_rtn_u32 v197, v196, v197
    s_mov_b64 exec, -1
    s_waitcnt lgkmcnt(0)
    v_readfirstlane_b32 s50, v197
    s_lshl_b32 s51, s47, 4
    s_lshl_b32 s52, s48, 1
    s_add_u32 s51, s51, s52
    s_and_b32 s52, s71, 1
    s_add_u32 s51, s51, s52
    s_lshl_b32 s51, s51, 7
    s_add_u32 s51, s51, 0x1820000
    s_cmp_lg_u32 s50, 7
    s_cbranch_scc1 L_nf2_41
    v_mov_b32 v196, s78
    s_mov_b64 exec, 1
    buffer_store_dword v196, off, s[36:39], s51 sc1
    s_mov_b64 exec, -1
L_nf2_41:
    s_add_u32 m0, s67, 16384
    s_add_u32 s52, s81, 0x204000
    buffer_load_dwordx4 v2, s[36:39], s52 offen sc1 lds
    s_add_u32 m0, s67, 114688
    s_add_u32 s52, s81, 0x404000
    buffer_load_dwordx4 v2, s[36:39], s52 offen sc1 lds
    v_exp_f32 v18, v18
    v_exp_f32 v19, v19
    v_exp_f32 v20, v20
    v_exp_f32 v21, v21
    s_waitcnt lgkmcnt(2)
    v_smfmac_f32_32x32x32_bf16 v[52:67], v[232:235], v[12:19], v249
    s_mov_b64 exec, s[40:41]
    ds_read_b128 v[232:235], v248 offset:3584
    s_mov_b64 exec, -1
    v_exp_f32 v22, v22
    v_exp_f32 v23, v23
    v_exp_f32 v24, v24
    v_exp_f32 v25, v25
    s_waitcnt lgkmcnt(2)
    v_mfma_f32_32x32x16_bf16 v[4:19], v[224:227], v[220:223], v[36:51]
    ds_read_b128 v[224:227], v3 offset:5120
    v_exp_f32 v26, v26
    v_exp_f32 v27, v27
    v_exp_f32 v28, v28
    v_exp_f32 v29, v29
    s_waitcnt lgkmcnt(2)
    v_smfmac_f32_32x32x32_bf16 v[52:67], v[228:231], v[20:27], v249
    s_mov_b64 exec, s[40:41]
    ds_read_b128 v[228:231], v248 offset:4096
    s_mov_b64 exec, -1
    v_exp_f32 v30, v30
    v_exp_f32 v31, v31
    v_exp_f32 v32, v32
    v_exp_f32 v33, v33
    s_add_u32 m0, s67, 24576
    s_add_u32 s52, s81, 0x206000
    buffer_load_dwordx4 v2, s[36:39], s52 offen sc1 lds
    s_add_u32 m0, s67, 122880
    s_add_u32 s52, s81, 0x406000
    buffer_load_dwordx4 v2, s[36:39], s52 offen sc1 lds
    v_exp_f32 v34, v34
    v_exp_f32 v35, v35
    v_add_u32 v3, 4096, v3
    v_add_u32 v248, 4096, v248
    v_exp_f32 v4, v4
    v_exp_f32 v5, v5
    s_waitcnt lgkmcnt(2)
    v_smfmac_f32_32x32x32_bf16 v[52:67], v[232:235], v[28:35], v249
    s_mov_b64 exec, s[40:41]
    ds_read_b128 v[232:235], v248 offset:512
    s_mov_b64 exec, -1
    v_exp_f32 v6, v6
    v_exp_f32 v7, v7
    v_exp_f32 v8, v8
    v_exp_f32 v9, v9
    s_waitcnt lgkmcnt(2)
    v_mfma_f32_32x32x16_bf16 v[20:35], v[224:227], v[220:223], v[36:51]
    ds_read_b128 v[224:227], v3 offset:2048
    v_exp_f32 v10, v10
    v_exp_f32 v11, v11
    v_exp_f32 v12, v12
    v_exp_f32 v13, v13
    s_waitcnt lgkmcnt(2)
    v_smfmac_f32_32x32x32_bf16 v[52:67], v[228:231], v[4:11], v249
    s_mov_b64 exec, s[40:41]
    ds_read_b128 v[228:231], v248 offset:1024
    s_mov_b64 exec, -1
    v_exp_f32 v14, v14
    v_exp_f32 v15, v15
    v_exp_f32 v16, v16
    v_exp_f32 v17, v17
    s_add_u32 m0, s67, 32768
    s_add_u32 s52, s81, 0x208000
    buffer_load_dwordx4 v2, s[36:39], s52 offen sc1 lds
    s_add_u32 m0, s67, 131072
    s_add_u32 s52, s81, 0x408000
    buffer_load_dwordx4 v2, s[36:39], s52 offen sc1 lds
    v_exp_f32 v18, v18
    v_exp_f32 v19, v19
    v_exp_f32 v20, v20
    v_exp_f32 v21, v21
    s_waitcnt lgkmcnt(2)
    v_smfmac_f32_32x32x32_bf16 v[52:67], v[232:235], v[12:19], v249
    s_mov_b64 exec, s[40:41]
    ds_read_b128 v[232:235], v248 offset:1536
    s_mov_b64 exec, -1
    v_exp_f32 v22, v22
    v_exp_f32 v23, v23
    v_exp_f32 v24, v24
    v_exp_f32 v25, v25
    s_waitcnt lgkmcnt(2)
    v_mfma_f32_32x32x16_bf16 v[4:19], v[224:227], v[220:223], v[36:51]
    ds_read_b128 v[224:227], v3 offset:3072
    v_exp_f32 v26, v26
    v_exp_f32 v27, v27
    v_exp_f32 v28, v28
    v_exp_f32 v29, v29
    s_waitcnt lgkmcnt(2)
    v_smfmac_f32_32x32x32_bf16 v[52:67], v[228:231], v[20:27], v249
    s_mov_b64 exec, s[40:41]
    ds_read_b128 v[228:231], v248 offset:2048
    s_mov_b64 exec, -1
    v_exp_f32 v30, v30
    v_exp_f32 v31, v31
    v_exp_f32 v32, v32
    v_exp_f32 v33, v33
    s_add_u32 m0, s67, 40960
    s_add_u32 s52, s81, 0x20a000
    buffer_load_dwordx4 v2, s[36:39], s52 offen sc1 lds
    s_add_u32 m0, s67, 139264
    s_add_u32 s52, s81, 0x40a000
    buffer_load_dwordx4 v2, s[36:39], s52 offen sc1 lds
    v_exp_f32 v34, v34
    v_exp_f32 v35, v35
    v_exp_f32 v4, v4
    v_exp_f32 v5, v5
    s_waitcnt lgkmcnt(2)
    v_smfmac_f32_32x32x32_bf16 v[52:67], v[232:235], v[28:35], v249
    s_mov_b64 exec, s[40:41]
    ds_read_b128 v[232:235], v248 offset:2560
    s_mov_b64 exec, -1
    v_exp_f32 v6, v6
    v_exp_f32 v7, v7
    v_exp_f32 v8, v8
    v_exp_f32 v9, v9
    s_waitcnt lgkmcnt(2)
    v_mfma_f32_32x32x16_bf16 v[20:35], v[224:227], v[220:223], v[36:51]
    ds_read_b128 v[224:227], v3 offset:4096
    v_exp_f32 v10, v10
    v_exp_f32 v11, v11
    v_exp_f32 v12, v12
    v_exp_f32 v13, v13
    s_waitcnt lgkmcnt(2)
    v_smfmac_f32_32x32x32_bf16 v[52:67], v[228:231], v[4:11], v249
    s_mov_b64 exec, s[40:41]
    ds_read_b128 v[228:231], v248 offset:3072
    s_mov_b64 exec, -1
    v_exp_f32 v14, v14
    v_exp_f32 v15, v15
    v_exp_f32 v16, v16
    v_exp_f32 v17, v17
    s_add_u32 m0, s67, 49152
    s_add_u32 s52, s81, 0x20c000
    buffer_load_dwordx4 v2, s[36:39], s52 offen sc1 lds
    s_add_u32 m0, s67, 147456
    s_add_u32 s52, s81, 0x40c000
    buffer_load_dwordx4 v2, s[36:39], s52 offen sc1 lds
    v_exp_f32 v18, v18
    v_exp_f32 v19, v19
    v_exp_f32 v20, v20
    v_exp_f32 v21, v21
    s_waitcnt lgkmcnt(2)
    v_smfmac_f32_32x32x32_bf16 v[52:67], v[232:235], v[12:19], v249
    s_mov_b64 exec, s[40:41]
    ds_read_b128 v[232:235], v248 offset:3584
    s_mov_b64 exec, -1
    v_exp_f32 v22, v22
    v_exp_f32 v23, v23
    v_exp_f32 v24, v24
    v_exp_f32 v25, v25
    s_waitcnt lgkmcnt(2)
    v_mfma_f32_32x32x16_bf16 v[4:19], v[224:227], v[220:223], v[36:51]
    ds_read_b128 v[224:227], v3 offset:5120
    v_exp_f32 v26, v26
    v_exp_f32 v27, v27
    v_exp_f32 v28, v28
    v_exp_f32 v29, v29
    s_waitcnt lgkmcnt(2)
    v_smfmac_f32_32x32x32_bf16 v[52:67], v[228:231], v[20:27], v249
    s_mov_b64 exec, s[40:41]
    ds_read_b128 v[228:231], v248 offset:4096
    s_mov_b64 exec, -1
    v_exp_f32 v30, v30
    v_exp_f32 v31, v31
    v_exp_f32 v32, v32
    v_exp_f32 v33, v33
    s_add_u32 m0, s67, 57344
    s_add_u32 s52, s81, 0x20e000
    buffer_load_dwordx4 v2, s[36:39], s52 offen sc1 lds
    s_add_u32 m0, s67, 155648
    s_add_u32 s52, s81, 0x40e000
    buffer_load_dwordx4 v2, s[36:39], s52 offen sc1 lds
    s_cmp_eq_u32 s44, 0
    s_cbranch_scc1 L_pr_42
    s_setprio 0
L_pr_42:
    v_exp_f32 v34, v34
    v_exp_f32 v35, v35
    v_add_u32 v3, 4096, v3
    v_add_u32 v248, 4096, v248
    v_exp_f32 v4, v4
    v_exp_f32 v5, v5
    s_waitcnt lgkmcnt(2)
    v_smfmac_f32_32x32x32_bf16 v[52:67], v[232:235], v[28:35], v249
    s_mov_b64 exec, s[40:41]
    ds_read_b128 v[232:235], v248 offset:512
    s_mov_b64 exec, -1
    v_exp_f32 v6, v6
    v_exp_f32 v7, v7
    v_exp_f32 v8, v8
    v_exp_f32 v9, v9
    s_waitcnt lgkmcnt(2)
    v_mfma_f32_32x32x16_bf16 v[20:35], v[224:227], v[220:223], v[36:51]
    ds_read_b128 v[224:227], v3 offset:2048
    v_exp_f32 v10, v10
    v_exp_f32 v11, v11
    v_exp_f32 v12, v12
    v_exp_f32 v13, v13
    s_waitcnt lgkmcnt(2)
    v_smfmac_f32_32x32x32_bf16 v[52:67], v[228:231], v[4:11], v249
    s_mov_b64 exec, s[40:41]
    ds_read_b128 v[228:231], v248 offset:1024
    s_mov_b64 exec, -1
    v_exp_f32 v14, v14
    v_exp_f32 v15, v15
    v_exp_f32 v16, v16
    v_exp_f32 v17, v17
    v_exp_f32 v18, v18
    v_exp_f32 v19, v19
    v_exp_f32 v20, v20
    v_exp_f32 v21, v21
    s_waitcnt lgkmcnt(2)
    v_smfmac_f32_32x32x32_bf16 v[52:67], v[232:235], v[12:19], v249
    s_mov_b64 exec, s[40:41]
    ds_read_b128 v[232:235], v248 offset:1536
    s_mov_b64 exec, -1
    v_exp_f32 v22, v22
    v_exp_f32 v23, v23
    v_exp_f32 v24, v24
    v_exp_f32 v25, v25
    s_waitcnt lgkmcnt(2)
    v_mfma_f32_32x32x16_bf16 v[4:19], v[224:227], v[220:223], v[36:51]
    ds_read_b128 v[224:227], v3 offset:3072
    v_exp_f32 v26, v26
    v_exp_f32 v27, v27
    v_exp_f32 v28, v28
    v_exp_f32 v29, v29
    s_waitcnt lgkmcnt(2)
    v_smfmac_f32_32x32x32_bf16 v[52:67], v[228:231], v[20:27], v249
    s_mov_b64 exec, s[40:41]
    ds_read_b128 v[228:231], v248 offset:2048
    s_mov_b64 exec, -1
    v_exp_f32 v30, v30
    v_exp_f32 v31, v31
    v_exp_f32 v32, v32
    v_exp_f32 v33, v33
    v_exp_f32 v34, v34
    v_exp_f32 v35, v35
    v_exp_f32 v4, v4
    v_exp_f32 v5, v5
    s_waitcnt lgkmcnt(2)
    v_smfmac_f32_32x32x32_bf16 v[52:67], v[232:235], v[28:35], v249
    s_mov_b64 exec, s[40:41]
    ds_read_b128 v[232:235], v248 offset:2560
    s_mov_b64 exec, -1
    v_exp_f32 v6, v6
    v_exp_f32 v7, v7
    v_exp_f32 v8, v8
    v_exp_f32 v9, v9
    s_waitcnt lgkmcnt(2)
    v_mfma_f32_32x32x16_bf16 v[20:35], v[224:227], v[220:223], v[36:51]
    ds_read_b128 v[224:227], v3 offset:4096
    v_exp_f32 v10, v10
    v_exp_f32 v11, v11
    v_exp_f32 v12, v12
    v_exp_f32 v13, v13
    s_waitcnt lgkmcnt(2)
    v_smfmac_f32_32x32x32_bf16 v[52:67], v[228:231], v[4:11], v249
    s_mov_b64 exec, s[40:41]
    ds_read_b128 v[228:231], v248 offset:3072
    s_mov_b64 exec, -1
    v_exp_f32 v14, v14
    v_exp_f32 v15, v15
    v_exp_f32 v16, v16
    v_exp_f32 v17, v17
    s_lshr_b32 s80, s70, 2
    s_lshl_b32 s80, s80, 11
    s_add_u32 s80, s80, 0x1820000
    s_lshl_b32 s50, s43, 13
    s_add_u32 s50, s50, 0x1820000
    s_cmp_eq_u32 s42, 0
    s_cselect_b32 s80, s80, s50
    s_cselect_b32 s50, 15, 63
    v_and_b32 v133, s50, v0
    s_cselect_b32 s50, 7, 7
    v_lshlrev_b32 v133, s50, v133
    s_sub_u32 s50, s42, 1
    s_cmp_lt_u32 s50, 3
    s_cbranch_scc1 L_np2a_43
    buffer_load_dword v132, v133, s[36:39], s80 offen sc1
L_np2a_43:
    v_exp_f32 v18, v18
    v_exp_f32 v19, v19
    v_exp_f32 v20, v20
    v_exp_f32 v21, v21
    s_waitcnt lgkmcnt(2)
    v_smfmac_f32_32x32x32_bf16 v[52:67], v[232:235], v[12:19], v249
    s_mov_b64 exec, s[40:41]
    ds_read_b128 v[232:235], v248 offset:3584
    s_mov_b64 exec, -1
    v_exp_f32 v22, v22
    v_exp_f32 v23, v23
    v_exp_f32 v24, v24
    v_exp_f32 v25, v25
    s_waitcnt lgkmcnt(2)
    v_mfma_f32_32x32x16_bf16 v[4:19], v[224:227], v[220:223], v[36:51]
    ds_read_b128 v[224:227], v3 offset:5120
    v_exp_f32 v26, v26
    v_exp_f32 v27, v27
    v_exp_f32 v28, v28
    v_exp_f32 v29, v29
    s_waitcnt lgkmcnt(2)
    v_smfmac_f32_32x32x32_bf16 v[52:67], v[228:231], v[20:27], v249
    s_mov_b64 exec, s[40:41]
    ds_read_b128 v[228:231], v248 offset:4096
    s_mov_b64 exec, -1
    v_exp_f32 v30, v30
    v_exp_f32 v31, v31
    v_exp_f32 v32, v32
    v_exp_f32 v33, v33
    v_exp_f32 v34, v34
    v_exp_f32 v35, v35
    v_add_u32 v3, 4096, v3
    v_add_u32 v248, 4096, v248
    s_sub_u32 s50, s42, 1
    s_cmp_lt_u32 s50, 3
    s_cbranch_scc1 L_np2_44
    s_mov_b32 s79, 0x40000
L_poll_45:
    s_waitcnt vmcnt(0)
    v_cmp_ne_u32 vcc, s78, v132
    s_nop 0
    s_cbranch_vccz L_polld_46
    buffer_load_dword v132, v133, s[36:39], s80 offen sc1
    s_sub_u32 s79, s79, 1
    s_cmp_lg_u32 s79, 0
    s_cbranch_scc1 L_poll_45
    s_waitcnt vmcnt(0)
L_polld_46:
L_np2_44:
    s_waitcnt vmcnt(0)
    s_barrier
    s_or_b32 s50, s2, s42
    s_cbranch_scc1 L_nep_47
    s_mov_b32 s50, 0x1800000
    v_mov_b32 v132, s78
    s_mov_b64 exec, 1
    buffer_store_dword v132, off, s[36:39], s50 sc1
    s_mov_b64 exec, -1
L_nep_47:
    s_cmp_eq_u32 s44, 0
    s_cbranch_scc1 L_pr_48
    s_setprio 1
L_pr_48:
    buffer_load_dwordx4 v[212:215], v2, s[36:39], s72 offen sc1
    s_add_u32 s72, s72, 1024
    buffer_load_dwordx4 v[196:199], v2, s[36:39], s73 offen offset:0 sc1
    buffer_load_dwordx4 v[200:203], v2, s[36:39], s73 offen offset:1024 sc1
    buffer_load_dwordx4 v[204:207], v2, s[36:39], s73 offen offset:2048 sc1
    buffer_load_dwordx4 v[208:211], v2, s[36:39], s73 offen offset:3072 sc1
    s_add_u32 s73, s73, 16384
    buffer_load_dwordx4 v[216:219], v2, s[36:39], s72 offen sc1
    s_add_u32 s72, s72, 1024
    v_exp_f32 v4, v4
    v_exp_f32 v5, v5
    s_waitcnt lgkmcnt(2)
    v_smfmac_f32_32x32x32_bf16 v[52:67], v[232:235], v[28:35], v249
    s_mov_b64 exec, s[40:41]
    ds_read_b128 v[232:235], v248 offset:512
    s_mov_b64 exec, -1
    v_exp_f32 v6, v6
    v_exp_f32 v7, v7
    v_exp_f32 v8, v8
    v_exp_f32 v9, v9
    s_waitcnt lgkmcnt(2)
    v_mfma_f32_32x32x16_bf16 v[20:35], v[224:227], v[220:223], v[36:51]
    ds_read_b128 v[224:227], v3 offset:2048
    v_exp_f32 v10, v10
    v_exp_f32 v11, v11
    v_exp_f32 v12, v12
    v_exp_f32 v13, v13
    s_waitcnt lgkmcnt(2)
    v_smfmac_f32_32x32x32_bf16 v[52:67], v[228:231], v[4:11], v249
    s_mov_b64 exec, s[40:41]
    ds_read_b128 v[228:231], v248 offset:1024
    s_mov_b64 exec, -1
    v_exp_f32 v14, v14
    v_exp_f32 v15, v15
    v_exp_f32 v16, v16
    v_exp_f32 v17, v17
    v_exp_f32 v18, v18
    v_exp_f32 v19, v19
    v_exp_f32 v20, v20
    v_exp_f32 v21, v21
    s_waitcnt lgkmcnt(2)
    v_smfmac_f32_32x32x32_bf16 v[52:67], v[232:235], v[12:19], v249
    s_mov_b64 exec, s[40:41]
    ds_read_b128 v[232:235], v248 offset:1536
    s_mov_b64 exec, -1
    v_exp_f32 v22, v22
    v_exp_f32 v23, v23
    v_exp_f32 v24, v24
    v_exp_f32 v25, v25
    s_waitcnt lgkmcnt(2)
    v_mfma_f32_32x32x16_bf16 v[4:19], v[224:227], v[220:223], v[36:51]
    ds_read_b128 v[224:227], v3 offset:3072
    v_exp_f32 v26, v26
    v_exp_f32 v27, v27
    v_exp_f32 v28, v28
    v_exp_f32 v29, v29
    s_waitcnt lgkmcnt(2)
    v_smfmac_f32_32x32x32_bf16 v[52:67], v[228:231], v[20:27], v249
    s_mov_b64 exec, s[40:41]
    ds_read_b128 v[228:231], v248 offset:2048
    s_mov_b64 exec, -1
    v_exp_f32 v30, v30
    v_exp_f32 v31, v31
    v_exp_f32 v32, v32
    v_exp_f32 v33, v33
    v_exp_f32 v34, v34
    v_exp_f32 v35, v35
    v_exp_f32 v4, v4
    v_exp_f32 v5, v5
    s_waitcnt lgkmcnt(2)
    v_smfmac_f32_32x32x32_bf16 v[52:67], v[232:235], v[28:35], v249
    s_mov_b64 exec, s[40:41]
    ds_read_b128 v[232:235], v248 offset:2560
    s_mov_b64 exec, -1
    v_exp_f32 v6, v6
    v_exp_f32 v7, v7
    v_exp_f32 v8, v8
    v_exp_f32 v9, v9
    s_waitcnt lgkmcnt(2)
    v_mfma_f32_32x32x16_bf16 v[20:35], v[224:227], v[220:223], v[36:51]
    ds_read_b128 v[224:227], v3 offset:4096
    v_exp_f32 v10, v10
    v_exp_f32 v11, v11
    v_exp_f32 v12, v12
    v_exp_f32 v13, v13
    s_waitcnt lgkmcnt(2)
    v_smfmac_f32_32x32x32_bf16 v[52:67], v[228:231], v[4:11], v249
    s_mov_b64 exec, s[40:41]
    ds_read_b128 v[228:231], v248 offset:3072
    s_mov_b64 exec, -1
    v_exp_f32 v14, v14
    v_exp_f32 v15, v15
    v_exp_f32 v16, v16
    v_exp_f32 v17, v17
    s_waitcnt vmcnt(4)
    v_mfma_f32_32x32x16_bf16 v[68:83], v[196:199], v[212:215], 0
    buffer_load_dwordx4 v[196:199], v2, s[36:39], s73 offen offset:0 sc1
    v_exp_f32 v18, v18
    v_exp_f32 v19, v19
    v_exp_f32 v20, v20
    v_exp_f32 v21, v21
    s_waitcnt lgkmcnt(2)
    v_smfmac_f32_32x32x32_bf16 v[52:67], v[232:235], v[12:19], v249
    s_mov_b64 exec, s[40:41]
    ds_read_b128 v[232:235], v248 offset:3584
    s_mov_b64 exec, -1
    v_exp_f32 v22, v22
    v_exp_f32 v23, v23
    v_exp_f32 v24, v24
    v_exp_f32 v25, v25
    s_waitcnt lgkmcnt(2)
    v_mfma_f32_32x32x16_bf16 v[4:19], v[224:227], v[220:223], v[36:51]
    ds_read_b128 v[224:227], v3 offset:5120
    v_exp_f32 v26, v26
    v_exp_f32 v27, v27
    v_exp_f32 v28, v28
    v_exp_f32 v29, v29
    s_waitcnt lgkmcnt(2)
    v_smfmac_f32_32x32x32_bf16 v[52:67], v[228:231], v[20:27], v249
    s_mov_b64 exec, s[40:41]
    ds_read_b128 v[228:231], v248 offset:4096
    s_mov_b64 exec, -1
    v_exp_f32 v30, v30
    v_exp_f32 v31, v31
    v_exp_f32 v32, v32
    v_exp_f32 v33, v33
    s_waitcnt vmcnt(4)
    v_mfma_f32_32x32x16_bf16 v[84:99], v[200:203], v[212:215], 0
    buffer_load_dwordx4 v[200:203], v2, s[36:39], s73 offen offset:1024 sc1
    v_exp_f32 v34, v34
    v_exp_f32 v35, v35
    v_add_u32 v3, 4096, v3
    v_add_u32 v248, 4096, v248
    v_exp_f32 v4, v4
    v_exp_f32 v5, v5
    s_waitcnt lgkmcnt(2)
    v_smfmac_f32_32x32x32_bf16 v[52:67], v[232:235], v[28:35], v249
    s_mov_b64 exec, s[40:41]
    ds_read_b128 v[232:235], v248 offset:512
    s_mov_b64 exec, -1
    v_exp_f32 v6, v6
    v_exp_f32 v7, v7
    v_exp_f32 v8, v8
    v_exp_f32 v9, v9
    s_waitcnt lgkmcnt(2)
    v_mfma_f32_32x32x16_bf16 v[20:35], v[224:227], v[220:223], v[36:51]
    ds_read_b128 v[224:227], v3 offset:2048
    v_exp_f32 v10, v10
    v_exp_f32 v11, v11
    v_exp_f32 v12, v12
    v_exp_f32 v13, v13
    s_waitcnt lgkmcnt(2)
    v_smfmac_f32_32x32x32_bf16 v[52:67], v[228:231], v[4:11], v249
    s_mov_b64 exec, s[40:41]
    ds_read_b128 v[228:231], v248 offset:1024
    s_mov_b64 exec, -1
    v_exp_f32 v14, v14
    v_exp_f32 v15, v15
    v_exp_f32 v16, v16
    v_exp_f32 v17, v17
    s_waitcnt vmcnt(4)
    v_mfma_f32_32x32x16_bf16 v[100:115], v[204:207], v[212:215], 0
    buffer_load_dwordx4 v[204:207], v2, s[36:39], s73 offen offset:2048 sc1
    v_exp_f32 v18, v18
    v_exp_f32 v19, v19
    v_exp_f32 v20, v20
    v_exp_f32 v21, v21
    s_waitcnt lgkmcnt(2)
    v_smfmac_f32_32x32x32_bf16 v[52:67], v[232:235], v[12:19], v249
    s_mov_b64 exec, s[40:41]
    ds_read_b128 v[232:235], v248 offset:1536
    s_mov_b64 exec, -1
    v_exp_f32 v22, v22
    v_exp_f32 v23, v23
    v_exp_f32 v24, v24
    s_waitcnt lgkmcnt(2)
    v_mfma_f32_32x32x16_bf16 v[4:19], v[224:227], v[220:223], v[36:51]
    ds_read_b128 v[224:227], v3 offset:3072
    v_exp_f32 v25, v25
    v_exp_f32 v26, v26
    v_exp_f32 v27, v27
    s_waitcnt vmcnt(4)
    v_mfma_f32_32x32x16_bf16 v[116:131], v[208:211], v[212:215], 0
    buffer_load_dwordx4 v[208:211], v2, s[36:39], s73 offen offset:3072 sc1
    s_add_u32 s73, s73, 16384
    buffer_load_dwordx4 v[212:215], v2, s[36:39], s72 offen sc1
    s_add_u32 s72, s72, 1024
    v_exp_f32 v28, v28
    v_exp_f32 v29, v29
    v_exp_f32 v30, v30
    s_waitcnt lgkmcnt(2)
    v_smfmac_f32_32x32x32_bf16 v[52:67], v[228:231], v[20:27], v249
    s_mov_b64 exec, s[40:41]
    ds_read_b128 v[228:231], v248 offset:2048
    s_mov_b64 exec, -1
    v_exp_f32 v31, v31
    v_exp_f32 v32, v32
    v_exp_f32 v33, v33
    s_waitcnt vmcnt(4)
    v_mfma_f32_32x32x16_bf16 v[68:83], v[196:199], v[216:219], v[68:83]
    buffer_load_dwordx4 v[196:199], v2, s[36:39], s73 offen offset:0 sc1
    v_exp_f32 v34, v34
    v_exp_f32 v35, v35
    v_exp_f32 v4, v4
    v_exp_f32 v5, v5
    s_waitcnt lgkmcnt(2)
    v_smfmac_f32_32x32x32_bf16 v[52:67], v[232:235], v[28:35], v249
    s_mov_b64 exec, s[40:41]
    ds_read_b128 v[232:235], v248 offset:2560
    s_mov_b64 exec, -1
    v_exp_f32 v6, v6
    v_exp_f32 v7, v7
    v_exp_f32 v8, v8
    v_exp_f32 v9, v9
    s_waitcnt lgkmcnt(2)
    v_mfma_f32_32x32x16_bf16 v[20:35], v[224:227], v[220:223], v[36:51]
    ds_read_b128 v[224:227], v3 offset:4096
    v_exp_f32 v10, v10
    v_exp_f32 v11, v11
    v_exp_f32 v12, v12
    v_exp_f32 v13, v13
    s_waitcnt lgkmcnt(2)
    v_smfmac_f32_32x32x32_bf16 v[52:67], v[228:231], v[4:11], v249
    s_mov_b64 exec, s[40:41]
    ds_read_b128 v[228:231], v248 offset:3072
    s_mov_b64 exec, -1
    v_exp_f32 v14, v14
    v_exp_f32 v15, v15
    v_exp_f32 v16, v16
    v_exp_f32 v17, v17
    s_waitcnt vmcnt(4)
    v_mfma_f32_32x32x16_bf16 v[84:99], v[200:203], v[216:219], v[84:99]
    buffer_load_dwordx4 v[200:203], v2, s[36:39], s73 offen offset:1024 sc1
    v_exp_f32 v18, v18
    v_exp_f32 v19, v19
    v_exp_f32 v20, v20
    v_exp_f32 v21, v21
    s_waitcnt lgkmcnt(2)
    v_smfmac_f32_32x32x32_bf16 v[52:67], v[232:235], v[12:19], v249
    s_mov_b64 exec, s[40:41]
    ds_read_b128 v[232:235], v248 offset:3584
    s_mov_b64 exec, -1
    v_exp_f32 v22, v22
    v_exp_f32 v23, v23
    v_exp_f32 v24, v24
    v_exp_f32 v25, v25
    s_waitcnt lgkmcnt(2)
    v_mfma_f32_32x32x16_bf16 v[4:19], v[224:227], v[220:223], v[36:51]
    ds_read_b128 v[224:227], v3 offset:5120
    v_exp_f32 v26, v26
    v_exp_f32 v27, v27
    v_exp_f32 v28, v28
    v_exp_f32 v29, v29
    s_waitcnt lgkmcnt(2)
    v_smfmac_f32_32x32x32_bf16 v[52:67], v[228:231], v[20:27], v249
    s_mov_b64 exec, s[40:41]
    ds_read_b128 v[228:231], v248 offset:4096
    s_mov_b64 exec, -1
    v_exp_f32 v30, v30
    v_exp_f32 v31, v31
    v_exp_f32 v32, v32
    v_exp_f32 v33, v33
    s_waitcnt vmcnt(4)
    v_mfma_f32_32x32x16_bf16 v[100:115], v[204:207], v[216:219], v[100:115]
    buffer_load_dwordx4 v[204:207], v2, s[36:39], s73 offen offset:2048 sc1
    v_exp_f32 v34, v34
    v_exp_f32 v35, v35
    v_add_u32 v3, 4096, v3
    v_add_u32 v248, 4096, v248
    v_exp_f32 v4, v4
    v_exp_f32 v5, v5
    s_waitcnt lgkmcnt(2)
    v_smfmac_f32_32x32x32_bf16 v[52:67], v[232:235], v[28:35], v249
    s_mov_b64 exec, s[40:41]
    ds_read_b128 v[232:235], v248 offset:512
    s_mov_b64 exec, -1
    v_exp_f32 v6, v6
    v_exp_f32 v7, v7
    v_exp_f32 v8, v8
    v_exp_f32 v9, v9
    s_waitcnt lgkmcnt(2)
    v_mfma_f32_32x32x16_bf16 v[20:35], v[224:227], v[220:223], v[36:51]
    ds_read_b128 v[224:227], v3 offset:2048
    v_exp_f32 v10, v10
    v_exp_f32 v11, v11
    v_exp_f32 v12, v12
    v_exp_f32 v13, v13
    s_waitcnt lgkmcnt(2)
    v_smfmac_f32_32x32x32_bf16 v[52:67], v[228:231], v[4:11], v249
    s_mov_b64 exec, s[40:41]
    ds_read_b128 v[228:231], v248 offset:1024
    s_mov_b64 exec, -1
    v_exp_f32 v14, v14
    v_exp_f32 v15, v15
    v_exp_f32 v16, v16
    v_exp_f32 v17, v17
    s_waitcnt vmcnt(4)
    v_mfma_f32_32x32x16_bf16 v[116:131], v[208:211], v[216:219], v[116:131]
    buffer_load_dwordx4 v[208:211], v2, s[36:39], s73 offen offset:3072 sc1
    s_add_u32 s73, s73, 16384
    buffer_load_dwordx4 v[216:219], v2, s[36:39], s72 offen sc1
    s_add_u32 s72, s72, 1024
    v_exp_f32 v18, v18
    v_exp_f32 v19, v19
    v_exp_f32 v20, v20
    v_exp_f32 v21, v21
    s_waitcnt lgkmcnt(2)
    v_smfmac_f32_32x32x32_bf16 v[52:67], v[232:235], v[12:19], v249
    s_mov_b64 exec, s[40:41]
    ds_read_b128 v[232:235], v248 offset:1536
    s_mov_b64 exec, -1
    v_exp_f32 v22, v22
    v_exp_f32 v23, v23
    v_exp_f32 v24, v24
    s_waitcnt lgkmcnt(2)
    v_mfma_f32_32x32x16_bf16 v[4:19], v[224:227], v[220:223], v[36:51]
    ds_read_b128 v[224:227], v3 offset:3072
    v_exp_f32 v25, v25
    v_exp_f32 v26, v26
    v_exp_f32 v27, v27
    s_waitcnt vmcnt(4)
    v_mfma_f32_32x32x16_bf16 v[68:83], v[196:199], v[212:215], v[68:83]
    buffer_load_dwordx4 v[196:199], v2, s[36:39], s73 offen offset:0 sc1
    v_exp_f32 v28, v28
    v_exp_f32 v29, v29
    v_exp_f32 v30, v30
    s_waitcnt lgkmcnt(2)
    v_smfmac_f32_32x32x32_bf16 v[52:67], v[228:231], v[20:27], v249
    s_mov_b64 exec, s[40:41]
    ds_read_b128 v[228:231], v248 offset:2048
    s_mov_b64 exec, -1
    v_exp_f32 v31, v31
    v_exp_f32 v32, v32
    v_exp_f32 v33, v33
    s_waitcnt vmcnt(4)
    v_mfma_f32_32x32x16_bf16 v[84:99], v[200:203], v[212:215], v[84:99]
    buffer_load_dwordx4 v[200:203], v2, s[36:39], s73 offen offset:1024 sc1
    v_exp_f32 v34, v34
    v_exp_f32 v35, v35
    v_exp_f32 v4, v4
    v_exp_f32 v5, v5
    s_waitcnt lgkmcnt(2)
    v_smfmac_f32_32x32x32_bf16 v[52:67], v[232:235], v[28:35], v249
    s_mov_b64 exec, s[40:41]
    ds_read_b128 v[232:235], v248 offset:2560
    s_mov_b64 exec, -1
    v_exp_f32 v6, v6
    v_exp_f32 v7, v7
    v_exp_f32 v8, v8
    v_exp_f32 v9, v9
    s_waitcnt lgkmcnt(2)
    v_mfma_f32_32x32x16_bf16 v[20:35], v[224:227], v[220:223], v[36:51]
    ds_read_b128 v[224:227], v3 offset:4096
    v_exp_f32 v10, v10
    v_exp_f32 v11, v11
    v_exp_f32 v12, v12
    v_exp_f32 v13, v13
    s_waitcnt lgkmcnt(2)
    v_smfmac_f32_32x32x32_bf16 v[52:67], v[228:231], v[4:11], v249
    s_mov_b64 exec, s[40:41]
    ds_read_b128 v[228:231], v248 offset:3072
    s_mov_b64 exec, -1
    v_exp_f32 v14, v14
    v_exp_f32 v15, v15
    v_exp_f32 v16, v16
    v_exp_f32 v17, v17
    s_waitcnt vmcnt(4)
    v_mfma_f32_32x32x16_bf16 v[100:115], v[204:207], v[212:215], v[100:115]
    buffer_load_dwordx4 v[204:207], v2, s[36:39], s73 offen offset:2048 sc1
    v_exp_f32 v18, v18
    v_exp_f32 v19, v19
    v_exp_f32 v20, v20
    v_exp_f32 v21, v21
    s_waitcnt lgkmcnt(2)
    v_smfmac_f32_32x32x32_bf16 v[52:67], v[232:235], v[12:19], v249
    s_mov_b64 exec, s[40:41]
    ds_read_b128 v[232:235], v248 offset:3584
    s_mov_b64 exec, -1
    v_exp_f32 v22, v22
    v_exp_f32 v23, v23
    v_exp_f32 v24, v24
    v_exp_f32 v25, v25
    s_waitcnt lgkmcnt(2)
    v_mfma_f32_32x32x16_bf16 v[4:19], v[224:227], v[220:223], v[36:51]
    ds_read_b128 v[224:227], v3 offset:5120
    v_exp_f32 v26, v26
    v_exp_f32 v27, v27
    v_exp_f32 v28, v28
    v_exp_f32 v29, v29
    s_waitcnt lgkmcnt(2)
    v_smfmac_f32_32x32x32_bf16 v[52:67], v[228:231], v[20:27], v249
    s_mov_b64 exec, s[40:41]
    ds_read_b128 v[228:231], v248 offset:4096
    s_mov_b64 exec, -1
    v_exp_f32 v30, v30
    v_exp_f32 v31, v31
    v_exp_f32 v32, v32
    v_exp_f32 v33, v33
    s_waitcnt vmcnt(4)
    v_mfma_f32_32x32x16_bf16 v[116:131], v[208:211], v[212:215], v[116:131]
    buffer_load_dwordx4 v[208:211], v2, s[36:39], s73 offen offset:3072 sc1
    s_add_u32 s73, s73, 16384
    buffer_load_dwordx4 v[212:215], v2, s[36:39], s72 offen sc1
    s_add_u32 s72, s72, 1024
    v_exp_f32 v34, v34
    v_exp_f32 v35, v35
    v_add_u32 v3, 4096, v3
    v_add_u32 v248, 4096, v248
    s_mov_b32 s76, 3
.p2align 6
L_attn_49:
    v_exp_f32 v4, v4
    v_exp_f32 v5, v5
    s_waitcnt lgkmcnt(2)
    v_smfmac_f32_32x32x32_bf16 v[52:67], v[232:235], v[28:35], v249
    s_mov_b64 exec, s[40:41]
    ds_read_b128 v[232:235], v248 offset:512
    s_mov_b64 exec, -1
    v_exp_f32 v6, v6
    v_exp_f32 v7, v7
    v_exp_f32 v8, v8
    v_exp_f32 v9, v9
    s_waitcnt lgkmcnt(2)
    v_mfma_f32_32x32x16_bf16 v[20:35], v[224:227], v[220:223], v[36:51]
    ds_read_b128 v[224:227], v3 offset:2048
    v_exp_f32 v10, v10
    v_exp_f32 v11, v11
    v_exp_f32 v12, v12
    v_exp_f32 v13, v13
    s_waitcnt lgkmcnt(2)
    v_smfmac_f32_32x32x32_bf16 v[52:67], v[228:231], v[4:11], v249
    s_mov_b64 exec, s[40:41]
    ds_read_b128 v[228:231], v248 offset:1024
    s_mov_b64 exec, -1
    v_exp_f32 v14, v14
    v_exp_f32 v15, v15
    v_exp_f32 v16, v16
    v_exp_f32 v17, v17
    s_waitcnt vmcnt(4)
    v_mfma_f32_32x32x16_bf16 v[68:83], v[196:199], v[216:219], v[68:83]
    buffer_load_dwordx4 v[196:199], v2, s[36:39], s73 offen offset:0 sc1
    v_exp_f32 v18, v18
    v_exp_f32 v19, v19
    v_exp_f32 v20, v20
    v_exp_f32 v21, v21
    s_waitcnt lgkmcnt(2)
    v_smfmac_f32_32x32x32_bf16 v[52:67], v[232:235], v[12:19], v249
    s_mov_b64 exec, s[40:41]
    ds_read_b128 v[232:235], v248 offset:1536
    s_mov_b64 exec, -1
    v_exp_f32 v22, v22
    v_exp_f32 v23, v23
    v_exp_f32 v24, v24
    v_exp_f32 v25, v25
    s_waitcnt lgkmcnt(2)
    v_mfma_f32_32x32x16_bf16 v[4:19], v[224:227], v[220:223], v[36:51]
    ds_read_b128 v[224:227], v3 offset:3072
    v_exp_f32 v26, v26
    v_exp_f32 v27, v27
    v_exp_f32 v28, v28
    v_exp_f32 v29, v29
    s_waitcnt lgkmcnt(2)
    v_smfmac_f32_32x32x32_bf16 v[52:67], v[228:231], v[20:27], v249
    s_mov_b64 exec, s[40:41]
    ds_read_b128 v[228:231], v248 offset:2048
    s_mov_b64 exec, -1
    v_exp_f32 v30, v30
    v_exp_f32 v31, v31
    v_exp_f32 v32, v32
    v_exp_f32 v33, v33
    s_waitcnt vmcnt(4)
    v_mfma_f32_32x32x16_bf16 v[84:99], v[200:203], v[216:219], v[84:99]
    buffer_load_dwordx4 v[200:203], v2, s[36:39], s73 offen offset:1024 sc1
    v_exp_f32 v34, v34
    v_exp_f32 v35, v35
    v_exp_f32 v4, v4
    v_exp_f32 v5, v5
    s_waitcnt lgkmcnt(2)
    v_smfmac_f32_32x32x32_bf16 v[52:67], v[232:235], v[28:35], v249
    s_mov_b64 exec, s[40:41]
    ds_read_b128 v[232:235], v248 offset:2560
    s_mov_b64 exec, -1
    v_exp_f32 v6, v6
    v_exp_f32 v7, v7
    v_exp_f32 v8, v8
    v_exp_f32 v9, v9
    s_waitcnt lgkmcnt(2)
    v_mfma_f32_32x32x16_bf16 v[20:35], v[224:227], v[220:223], v[36:51]
    ds_read_b128 v[224:227], v3 offset:4096
    v_exp_f32 v10, v10
    v_exp_f32 v11, v11
    v_exp_f32 v12, v12
    v_exp_f32 v13, v13
    s_waitcnt lgkmcnt(2)
    v_smfmac_f32_32x32x32_bf16 v[52:67], v[228:231], v[4:11], v249
    s_mov_b64 exec, s[40:41]
    ds_read_b128 v[228:231], v248 offset:3072
    s_mov_b64 exec, -1
    v_exp_f32 v14, v14
    v_exp_f32 v15, v15
    v_exp_f32 v16, v16
    v_exp_f32 v17, v17
    s_waitcnt vmcnt(4)
    v_mfma_f32_32x32x16_bf16 v[100:115], v[204:207], v[216:219], v[100:115]
    buffer_load_dwordx4 v[204:207], v2, s[36:39], s73 offen offset:2048 sc1
    v_exp_f32 v18, v18
    v_exp_f32 v19, v19
    v_exp_f32 v20, v20
    v_exp_f32 v21, v21
    s_waitcnt lgkmcnt(2)
    v_smfmac_f32_32x32x32_bf16 v[52:67], v[232:235], v[12:19], v249
    s_mov_b64 exec, s[40:41]
    ds_read_b128 v[232:235], v248 offset:3584
    s_mov_b64 exec, -1
    v_exp_f32 v22, v22
    v_exp_f32 v23, v23
    v_exp_f32 v24, v24
    v_exp_f32 v25, v25
    s_waitcnt lgkmcnt(2)
    v_mfma_f32_32x32x16_bf16 v[4:19], v[224:227], v[220:223], v[36:51]
    ds_read_b128 v[224:227], v3 offset:5120
    v_exp_f32 v26, v26
    v_exp_f32 v27, v27
    v_exp_f32 v28, v28
    v_exp_f32 v29, v29
    s_waitcnt lgkmcnt(2)
    v_smfmac_f32_32x32x32_bf16 v[52:67], v[228:231], v[20:27], v249
    s_mov_b64 exec, s[40:41]
    ds_read_b128 v[228:231], v248 offset:4096
    s_mov_b64 exec, -1
    v_exp_f32 v30, v30
    v_exp_f32 v31, v31
    v_exp_f32 v32, v32
    v_exp_f32 v33, v33
    s_waitcnt vmcnt(4)
    v_mfma_f32_32x32x16_bf16 v[116:131], v[208:211], v[216:219], v[116:131]
    buffer_load_dwordx4 v[208:211], v2, s[36:39], s73 offen offset:3072 sc1
    s_add_u32 s73, s73, 16384
    buffer_load_dwordx4 v[216:219], v2, s[36:39], s72 offen sc1
    s_add_u32 s72, s72, 1024
    v_exp_f32 v34, v34
    v_exp_f32 v35, v35
    v_add_u32 v3, 4096, v3
    v_add_u32 v248, 4096, v248
    v_exp_f32 v4, v4
    v_exp_f32 v5, v5
    s_waitcnt lgkmcnt(2)
    v_smfmac_f32_32x32x32_bf16 v[52:67], v[232:235], v[28:35], v249
    s_mov_b64 exec, s[40:41]
    ds_read_b128 v[232:235], v248 offset:512
    s_mov_b64 exec, -1
    v_exp_f32 v6, v6
    v_exp_f32 v7, v7
    v_exp_f32 v8, v8
    v_exp_f32 v9, v9
    s_waitcnt lgkmcnt(2)
    v_mfma_f32_32x32x16_bf16 v[20:35], v[224:227], v[220:223], v[36:51]
    ds_read_b128 v[224:227], v3 offset:2048
    v_exp_f32 v10, v10
    v_exp_f32 v11, v11
    v_exp_f32 v12, v12
    v_exp_f32 v13, v13
    s_waitcnt lgkmcnt(2)
    v_smfmac_f32_32x32x32_bf16 v[52:67], v[228:231], v[4:11], v249
    s_mov_b64 exec, s[40:41]
    ds_read_b128 v[228:231], v248 offset:1024
    s_mov_b64 exec, -1
    v_exp_f32 v14, v14
    v_exp_f32 v15, v15
    v_exp_f32 v16, v16
    v_exp_f32 v17, v17
    s_waitcnt vmcnt(4)
    v_mfma_f32_32x32x16_bf16 v[68:83], v[196:199], v[212:215], v[68:83]
    buffer_load_dwordx4 v[196:199], v2, s[36:39], s73 offen offset:0 sc1
    s_cmp_lg_u32 s76, 1
    s_cbranch_scc1 L_prl_50
    s_setprio 0
L_prl_50:
    v_exp_f32 v18, v18
    v_exp_f32 v19, v19
    v_exp_f32 v20, v20
    v_exp_f32 v21, v21
    s_waitcnt lgkmcnt(2)
    v_smfmac_f32_32x32x32_bf16 v[52:67], v[232:235], v[12:19], v249
    s_mov_b64 exec, s[40:41]
    ds_read_b128 v[232:235], v248 offset:1536
    s_mov_b64 exec, -1
    v_exp_f32 v22, v22
    v_exp_f32 v23, v23
    v_exp_f32 v24, v24
    v_exp_f32 v25, v25
    s_waitcnt lgkmcnt(2)
    v_mfma_f32_32x32x16_bf16 v[4:19], v[224:227], v[220:223], v[36:51]
    ds_read_b128 v[224:227], v3 offset:3072
    v_exp_f32 v26, v26
    v_exp_f32 v27, v27
    v_exp_f32 v28, v28
    v_exp_f32 v29, v29
    s_waitcnt lgkmcnt(2)
    v_smfmac_f32_32x32x32_bf16 v[52:67], v[228:231], v[20:27], v249
    s_mov_b64 exec, s[40:41]
    ds_read_b128 v[228:231], v248 offset:2048
    s_mov_b64 exec, -1
    v_exp_f32 v30, v30
    v_exp_f32 v31, v31
    v_exp_f32 v32, v32
    v_exp_f32 v33, v33
    s_waitcnt vmcnt(4)
    v_mfma_f32_32x32x16_bf16 v[84:99], v[200:203], v[212:215], v[84:99]
    buffer_load_dwordx4 v[200:203], v2, s[36:39], s73 offen offset:1024 sc1
    v_exp_f32 v34, v34
    v_exp_f32 v35, v35
    v_exp_f32 v4, v4
    v_exp_f32 v5, v5
    s_waitcnt lgkmcnt(2)
    v_smfmac_f32_32x32x32_bf16 v[52:67], v[232:235], v[28:35], v249
    s_mov_b64 exec, s[40:41]
    ds_read_b128 v[232:235], v248 offset:2560
    s_mov_b64 exec, -1
    v_exp_f32 v6, v6
    v_exp_f32 v7, v7
    v_exp_f32 v8, v8
    v_exp_f32 v9, v9
    s_waitcnt lgkmcnt(2)
    v_mfma_f32_32x32x16_bf16 v[20:35], v[224:227], v[220:223], v[36:51]
    ds_read_b128 v[224:227], v3 offset:4096
    v_exp_f32 v10, v10
    v_exp_f32 v11, v11
    v_exp_f32 v12, v12
    v_exp_f32 v13, v13
    s_waitcnt lgkmcnt(2)
    v_smfmac_f32_32x32x32_bf16 v[52:67], v[228:231], v[4:11], v249
    s_mov_b64 exec, s[40:41]
    ds_read_b128 v[228:231], v248 offset:3072
    s_mov_b64 exec, -1
    v_exp_f32 v14, v14
    v_exp_f32 v15, v15
    v_exp_f32 v16, v16
    v_exp_f32 v17, v17
    s_waitcnt vmcnt(4)
    v_mfma_f32_32x32x16_bf16 v[100:115], v[204:207], v[212:215], v[100:115]
    buffer_load_dwordx4 v[204:207], v2, s[36:39], s73 offen offset:2048 sc1
    v_exp_f32 v18, v18
    v_exp_f32 v19, v19
    v_exp_f32 v20, v20
    v_exp_f32 v21, v21
    s_waitcnt lgkmcnt(2)
    v_smfmac_f32_32x32x32_bf16 v[52:67], v[232:235], v[12:19], v249
    s_mov_b64 exec, s[40:41]
    ds_read_b128 v[232:235], v248 offset:3584
    s_mov_b64 exec, -1
    v_exp_f32 v22, v22
    v_exp_f32 v23, v23
    v_exp_f32 v24, v24
    v_exp_f32 v25, v25
    s_waitcnt lgkmcnt(2)
    v_mfma_f32_32x32x16_bf16 v[4:19], v[224:227], v[220:223], v[36:51]
    ds_read_b128 v[224:227], v3 offset:5120
    v_exp_f32 v26, v26
    v_exp_f32 v27, v27
    v_exp_f32 v28, v28
    v_exp_f32 v29, v29
    s_waitcnt lgkmcnt(2)
    v_smfmac_f32_32x32x32_bf16 v[52:67], v[228:231], v[20:27], v249
    s_mov_b64 exec, s[40:41]
    ds_read_b128 v[228:231], v248 offset:4096
    s_mov_b64 exec, -1
    v_exp_f32 v30, v30
    v_exp_f32 v31, v31
    v_exp_f32 v32, v32
    v_exp_f32 v33, v33
    s_waitcnt vmcnt(4)
    v_mfma_f32_32x32x16_bf16 v[116:131], v[208:211], v[212:215], v[116:131]
    buffer_load_dwordx4 v[208:211], v2, s[36:39], s73 offen offset:3072 sc1
    s_add_u32 s73, s73, 16384
    buffer_load_dwordx4 v[212:215], v2, s[36:39], s72 offen sc1
    s_add_u32 s72, s72, 1024
    v_exp_f32 v34, v34
    v_exp_f32 v35, v35
    v_add_u32 v3, 4096, v3
    v_add_u32 v248, 4096, v248
    s_sub_u32 s76, s76, 1
    s_cmp_lg_u32 s76, 0
    s_cbranch_scc1 L_attn_49
    v_exp_f32 v4, v4
    v_exp_f32 v5, v5
    s_waitcnt lgkmcnt(2)
    v_smfmac_f32_32x32x32_bf16 v[52:67], v[232:235], v[28:35], v249
    s_mov_b64 exec, s[40:41]
    ds_read_b128 v[232:235], v248 offset:512
    s_mov_b64 exec, -1
    v_exp_f32 v6, v6
    v_exp_f32 v7, v7
    v_exp_f32 v8, v8
    v_exp_f32 v9, v9
    s_waitcnt lgkmcnt(2)
    v_mfma_f32_32x32x16_bf16 v[20:35], v[224:227], v[220:223], v[36:51]
    ds_read_b128 v[224:227], v3 offset:2048
    v_exp_f32 v10, v10
    v_exp_f32 v11, v11
    v_exp_f32 v12, v12
    v_exp_f32 v13, v13
    s_waitcnt lgkmcnt(2)
    v_smfmac_f32_32x32x32_bf16 v[52:67], v[228:231], v[4:11], v249
    s_mov_b64 exec, s[40:41]
    ds_read_b128 v[228:231], v248 offset:1024
    s_mov_b64 exec, -1
    v_exp_f32 v14, v14
    v_exp_f32 v15, v15
    v_exp_f32 v16, v16
    v_exp_f32 v17, v17
    s_waitcnt vmcnt(4)
    v_mfma_f32_32x32x16_bf16 v[68:83], v[196:199], v[216:219], v[68:83]
    buffer_load_dwordx4 v[196:199], v2, s[36:39], s73 offen offset:0 sc1
    buffer_load_dwordx4 v[132:135], v2, s[36:39], s74 offen sc1
    s_add_u32 s74, s74, 16384
    v_exp_f32 v18, v18
    v_exp_f32 v19, v19
    v_exp_f32 v20, v20
    v_exp_f32 v21, v21
    s_waitcnt lgkmcnt(2)
    v_smfmac_f32_32x32x32_bf16 v[52:67], v[232:235], v[12:19], v249
    s_mov_b64 exec, s[40:41]
    ds_read_b128 v[232:235], v248 offset:1536
    s_mov_b64 exec, -1
    v_exp_f32 v22, v22
    v_exp_f32 v23, v23
    v_exp_f32 v24, v24
    s_waitcnt lgkmcnt(2)
    v_mfma_f32_32x32x16_bf16 v[4:19], v[224:227], v[220:223], v[36:51]
    ds_read_b128 v[224:227], v3 offset:3072
    v_exp_f32 v25, v25
    v_exp_f32 v26, v26
    v_exp_f32 v27, v27
    s_waitcnt vmcnt(5)
    v_mfma_f32_32x32x16_bf16 v[84:99], v[200:203], v[216:219], v[84:99]
    buffer_load_dwordx4 v[200:203], v2, s[36:39], s73 offen offset:1024 sc1
    v_exp_f32 v28, v28
    v_exp_f32 v29, v29
    v_exp_f32 v30, v30
    s_waitcnt lgkmcnt(2)
    v_smfmac_f32_32x32x32_bf16 v[52:67], v[228:231], v[20:27], v249
    s_mov_b64 exec, s[40:41]
    ds_read_b128 v[228:231], v248 offset:2048
    s_mov_b64 exec, -1
    v_exp_f32 v31, v31
    v_exp_f32 v32, v32
    v_exp_f32 v33, v33
    s_waitcnt vmcnt(5)
    v_mfma_f32_32x32x16_bf16 v[100:115], v[204:207], v[216:219], v[100:115]
    buffer_load_dwordx4 v[204:207], v2, s[36:39], s73 offen offset:2048 sc1
    buffer_load_dwordx4 v[136:139], v2, s[36:39], s74 offen sc1
    s_add_u32 s74, s74, 16384
    v_exp_f32 v34, v34
    v_exp_f32 v35, v35
    v_exp_f32 v4, v4
    v_exp_f32 v5, v5
    s_waitcnt lgkmcnt(2)
    v_smfmac_f32_32x32x32_bf16 v[52:67], v[232:235], v[28:35], v249
    s_mov_b64 exec, s[40:41]
    ds_read_b128 v[232:235], v248 offset:2560
    s_mov_b64 exec, -1
    v_exp_f32 v6, v6
    v_exp_f32 v7, v7
    v_exp_f32 v8, v8
    v_exp_f32 v9, v9
    s_waitcnt lgkmcnt(2)
    v_mfma_f32_32x32x16_bf16 v[20:35], v[224:227], v[220:223], v[36:51]
    ds_read_b128 v[224:227], v3 offset:4096
    v_exp_f32 v10, v10
    v_exp_f32 v11, v11
    v_exp_f32 v12, v12
    v_exp_f32 v13, v13
    s_waitcnt lgkmcnt(2)
    v_smfmac_f32_32x32x32_bf16 v[52:67], v[228:231], v[4:11], v249
    s_mov_b64 exec, s[40:41]
    ds_read_b128 v[228:231], v248 offset:3072
    s_mov_b64 exec, -1
    v_exp_f32 v14, v14
    v_exp_f32 v15, v15
    v_exp_f32 v16, v16
    v_exp_f32 v17, v17
    s_waitcnt vmcnt(6)
    v_mfma_f32_32x32x16_bf16 v[116:131], v[208:211], v[216:219], v[116:131]
    buffer_load_dwordx4 v[208:211], v2, s[36:39], s73 offen offset:3072 sc1
    s_add_u32 s73, s73, 16384
    buffer_load_dwordx4 v[216:219], v2, s[36:39], s72 offen sc1
    s_add_u32 s72, s72, 1024
    buffer_load_dwordx4 v[140:143], v2, s[36:39], s74 offen sc1
    s_add_u32 s74, s74, 16384
    v_exp_f32 v18, v18
    v_exp_f32 v19, v19
    v_exp_f32 v20, v20
    v_exp_f32 v21, v21
    s_waitcnt lgkmcnt(2)
    v_smfmac_f32_32x32x32_bf16 v[52:67], v[232:235], v[12:19], v249
    s_mov_b64 exec, s[40:41]
    ds_read_b128 v[232:235], v248 offset:3584
    s_mov_b64 exec, -1
    v_exp_f32 v22, v22
    v_exp_f32 v23, v23
    v_exp_f32 v24, v24
    v_exp_f32 v25, v25
    s_waitcnt lgkmcnt(2)
    v_mfma_f32_32x32x16_bf16 v[4:19], v[224:227], v[220:223], v[36:51]
    ds_read_b128 v[224:227], v3 offset:5120
    v_exp_f32 v26, v26
    v_exp_f32 v27, v27
    v_exp_f32 v28, v28
    v_exp_f32 v29, v29
    s_waitcnt lgkmcnt(2)
    v_smfmac_f32_32x32x32_bf16 v[52:67], v[228:231], v[20:27], v249
    s_mov_b64 exec, s[40:41]
    ds_read_b128 v[228:231], v248 offset:4096
    s_mov_b64 exec, -1
    v_exp_f32 v30, v30
    v_exp_f32 v31, v31
    v_exp_f32 v32, v32
    v_exp_f32 v33, v33
    s_waitcnt vmcnt(7)
    v_mfma_f32_32x32x16_bf16 v[68:83], v[196:199], v[212:215], v[68:83]
    buffer_load_dwordx4 v[196:199], v2, s[36:39], s73 offen offset:0 sc1
    buffer_load_dwordx4 v[144:147], v2, s[36:39], s74 offen sc1
    s_add_u32 s74, s74, 16384
    v_exp_f32 v34, v34
    v_exp_f32 v35, v35
    v_add_u32 v3, 4096, v3
    v_add_u32 v248, 4096, v248
    v_exp_f32 v4, v4
    v_exp_f32 v5, v5
    s_waitcnt lgkmcnt(2)
    v_smfmac_f32_32x32x32_bf16 v[52:67], v[232:235], v[28:35], v249
    s_mov_b64 exec, s[40:41]
    ds_read_b128 v[232:235], v248 offset:512
    s_mov_b64 exec, -1
    v_exp_f32 v6, v6
    v_exp_f32 v7, v7
    v_exp_f32 v8, v8
    v_exp_f32 v9, v9
    s_waitcnt lgkmcnt(2)
    v_mfma_f32_32x32x16_bf16 v[20:35], v[224:227], v[220:223], v[36:51]
    ds_read_b128 v[224:227], v3 offset:2048
    v_exp_f32 v10, v10
    v_exp_f32 v11, v11
    v_exp_f32 v12, v12
    v_exp_f32 v13, v13
    s_waitcnt lgkmcnt(2)
    v_smfmac_f32_32x32x32_bf16 v[52:67], v[228:231], v[4:11], v249
    s_mov_b64 exec, s[40:41]
    ds_read_b128 v[228:231], v248 offset:1024
    s_mov_b64 exec, -1
    v_exp_f32 v14, v14
    v_exp_f32 v15, v15
    v_exp_f32 v16, v16
    v_exp_f32 v17, v17
    s_waitcnt vmcnt(7)
    v_mfma_f32_32x32x16_bf16 v[84:99], v[200:203], v[212:215], v[84:99]
    buffer_load_dwordx4 v[200:203], v2, s[36:39], s73 offen offset:1024 sc1
    buffer_load_dwordx4 v[148:151], v2, s[36:39], s74 offen sc1
    s_add_u32 s74, s74, 16384
    v_exp_f32 v18, v18
    v_exp_f32 v19, v19
    v_exp_f32 v20, v20
    v_exp_f32 v21, v21
    s_waitcnt lgkmcnt(2)
    v_smfmac_f32_32x32x32_bf16 v[52:67], v[232:235], v[12:19], v249
    s_mov_b64 exec, s[40:41]
    ds_read_b128 v[232:235], v248 offset:1536
    s_mov_b64 exec, -1
    v_exp_f32 v22, v22
    v_exp_f32 v23, v23
    v_exp_f32 v24, v24
    s_waitcnt lgkmcnt(2)
    v_mfma_f32_32x32x16_bf16 v[4:19], v[224:227], v[220:223], v[36:51]
    ds_read_b128 v[224:227], v3 offset:3072
    v_exp_f32 v25, v25
    v_exp_f32 v26, v26
    v_exp_f32 v27, v27
    s_waitcnt vmcnt(8)
    v_mfma_f32_32x32x16_bf16 v[100:115], v[204:207], v[212:215], v[100:115]
    buffer_load_dwordx4 v[204:207], v2, s[36:39], s73 offen offset:2048 sc1
    v_exp_f32 v28, v28
    v_exp_f32 v29, v29
    v_exp_f32 v30, v30
    s_waitcnt lgkmcnt(2)
    v_smfmac_f32_32x32x32_bf16 v[52:67], v[228:231], v[20:27], v249
    s_mov_b64 exec, s[40:41]
    ds_read_b128 v[228:231], v248 offset:2048
    s_mov_b64 exec, -1
    v_exp_f32 v31, v31
    v_exp_f32 v32, v32
    v_exp_f32 v33, v33
    s_waitcnt vmcnt(7)
    v_mfma_f32_32x32x16_bf16 v[116:131], v[208:211], v[212:215], v[116:131]
    buffer_load_dwordx4 v[208:211], v2, s[36:39], s73 offen offset:3072 sc1
    s_add_u32 s73, s73, 16384
    buffer_load_dwordx4 v[212:215], v2, s[36:39], s72 offen sc1
    s_add_u32 s72, s72, 1024
    buffer_load_dwordx4 v[152:155], v2, s[36:39], s74 offen sc1
    s_add_u32 s74, s74, 16384
    v_exp_f32 v34, v34
    v_exp_f32 v35, v35
    v_exp_f32 v4, v4
    v_exp_f32 v5, v5
    s_waitcnt lgkmcnt(2)
    v_smfmac_f32_32x32x32_bf16 v[52:67], v[232:235], v[28:35], v249
    s_mov_b64 exec, s[40:41]
    ds_read_b128 v[232:235], v248 offset:2560
    s_mov_b64 exec, -1
    v_exp_f32 v6, v6
    v_exp_f32 v7, v7
    v_exp_f32 v8, v8
    v_exp_f32 v9, v9
    s_waitcnt lgkmcnt(2)
    v_mfma_f32_32x32x16_bf16 v[20:35], v[224:227], v[220:223], v[36:51]
    ds_read_b128 v[224:227], v3 offset:4096
    v_exp_f32 v10, v10
    v_exp_f32 v11, v11
    v_exp_f32 v12, v12
    v_exp_f32 v13, v13
    s_waitcnt lgkmcnt(2)
    v_smfmac_f32_32x32x32_bf16 v[52:67], v[228:231], v[4:11], v249
    s_mov_b64 exec, s[40:41]
    ds_read_b128 v[228:231], v248 offset:3072
    s_mov_b64 exec, -1
    v_exp_f32 v14, v14
    v_exp_f32 v15, v15
    v_exp_f32 v16, v16
    v_exp_f32 v17, v17
    s_waitcnt vmcnt(7)
    v_mfma_f32_32x32x16_bf16 v[68:83], v[196:199], v[216:219], v[68:83]
    buffer_load_dwordx4 v[196:199], v2, s[36:39], s73 offen offset:0 sc1
    buffer_load_dwordx4 v[156:159], v2, s[36:39], s74 offen sc1
    s_add_u32 s74, s74, 16384
    v_exp_f32 v18, v18
    v_exp_f32 v19, v19
    v_exp_f32 v20, v20
    v_exp_f32 v21, v21
    s_waitcnt lgkmcnt(2)
    v_smfmac_f32_32x32x32_bf16 v[52:67], v[232:235], v[12:19], v249
    s_mov_b64 exec, s[40:41]
    ds_read_b128 v[232:235], v248 offset:3584
    s_mov_b64 exec, -1
    v_exp_f32 v22, v22
    v_exp_f32 v23, v23
    v_exp_f32 v24, v24
    v_exp_f32 v25, v25
    s_waitcnt lgkmcnt(2)
    v_mfma_f32_32x32x16_bf16 v[4:19], v[224:227], v[220:223], v[36:51]
    ds_read_b128 v[224:227], v3 offset:5120
    v_exp_f32 v26, v26
    v_exp_f32 v27, v27
    v_exp_f32 v28, v28
    v_exp_f32 v29, v29
    s_waitcnt lgkmcnt(2)
    v_smfmac_f32_32x32x32_bf16 v[52:67], v[228:231], v[20:27], v249
    s_mov_b64 exec, s[40:41]
    ds_read_b128 v[228:231], v248 offset:4096
    s_mov_b64 exec, -1
    v_exp_f32 v30, v30
    v_exp_f32 v31, v31
    v_exp_f32 v32, v32
    v_exp_f32 v33, v33
    s_waitcnt vmcnt(7)
    v_mfma_f32_32x32x16_bf16 v[84:99], v[200:203], v[216:219], v[84:99]
    buffer_load_dwordx4 v[200:203], v2, s[36:39], s73 offen offset:1024 sc1
    buffer_load_dwordx4 v[160:163], v2, s[36:39], s74 offen sc1
    s_add_u32 s74, s74, 16384
    v_exp_f32 v34, v34
    v_exp_f32 v35, v35
    v_add_u32 v3, 4096, v3
    v_add_u32 v248, 4096, v248
    v_exp_f32 v4, v4
    v_exp_f32 v5, v5
    s_waitcnt lgkmcnt(2)
    v_smfmac_f32_32x32x32_bf16 v[52:67], v[232:235], v[28:35], v249
    s_mov_b64 exec, s[40:41]
    ds_read_b128 v[232:235], v248 offset:512
    s_mov_b64 exec, -1
    v_exp_f32 v6, v6
    v_exp_f32 v7, v7
    v_exp_f32 v8, v8
    v_exp_f32 v9, v9
    s_waitcnt lgkmcnt(2)
    v_mfma_f32_32x32x16_bf16 v[20:35], v[224:227], v[220:223], v[36:51]
    ds_read_b128 v[224:227], v3 offset:2048
    v_exp_f32 v10, v10
    v_exp_f32 v11, v11
    v_exp_f32 v12, v12
    v_exp_f32 v13, v13
    s_waitcnt lgkmcnt(2)
    v_smfmac_f32_32x32x32_bf16 v[52:67], v[228:231], v[4:11], v249
    s_mov_b64 exec, s[40:41]
    ds_read_b128 v[228:231], v248 offset:1024
    s_mov_b64 exec, -1
    v_exp_f32 v14, v14
    v_exp_f32 v15, v15
    v_exp_f32 v16, v16
    v_exp_f32 v17, v17
    s_waitcnt vmcnt(7)
    v_mfma_f32_32x32x16_bf16 v[100:115], v[204:207], v[216:219], v[100:115]
    buffer_load_dwordx4 v[204:207], v2, s[36:39], s73 offen offset:2048 sc1
    buffer_load_dwordx4 v[164:167], v2, s[36:39], s74 offen sc1
    s_add_u32 s74, s74, 16384
    v_mov_b32 v244, 65540
    v_mov_b32 v245, 1
    s_mov_b64 exec, 1
    ds_add_u32 v244, v245
    s_mov_b64 exec, -1
    v_exp_f32 v18, v18
    v_exp_f32 v19, v19
    v_exp_f32 v20, v20
    v_exp_f32 v21, v21
    s_waitcnt lgkmcnt(2)
    v_smfmac_f32_32x32x32_bf16 v[52:67], v[232:235], v[12:19], v249
    s_mov_b64 exec, s[40:41]
    ds_read_b128 v[232:235], v248 offset:1536
    s_mov_b64 exec, -1
    v_exp_f32 v22, v22
    v_exp_f32 v23, v23
    v_exp_f32 v24, v24
    s_waitcnt lgkmcnt(2)
    v_mfma_f32_32x32x16_bf16 v[4:19], v[224:227], v[220:223], v[36:51]
    ds_read_b128 v[224:227], v3 offset:3072
    v_exp_f32 v25, v25
    v_exp_f32 v26, v26
    v_exp_f32 v27, v27
    s_waitcnt vmcnt(8)
    v_mfma_f32_32x32x16_bf16 v[116:131], v[208:211], v[216:219], v[116:131]
    buffer_load_dwordx4 v[208:211], v2, s[36:39], s73 offen offset:3072 sc1
    s_add_u32 s73, s73, 16384
    buffer_load_dwordx4 v[216:219], v2, s[36:39], s72 offen sc1
    s_add_u32 s72, s72, 1024
    v_exp_f32 v28, v28
    v_exp_f32 v29, v29
    v_exp_f32 v30, v30
    s_waitcnt lgkmcnt(2)
    v_smfmac_f32_32x32x32_bf16 v[52:67], v[228:231], v[20:27], v249
    s_mov_b64 exec, s[40:41]
    ds_read_b128 v[228:231], v248 offset:2048
    s_mov_b64 exec, -1
    v_exp_f32 v31, v31
    v_exp_f32 v32, v32
    v_exp_f32 v33, v33
    s_waitcnt vmcnt(7)
    v_mfma_f32_32x32x16_bf16 v[68:83], v[196:199], v[212:215], v[68:83]
    buffer_load_dwordx4 v[196:199], v2, s[36:39], s73 offen offset:0 sc1
    buffer_load_dwordx4 v[168:171], v2, s[36:39], s74 offen sc1
    s_add_u32 s74, s74, 16384
    v_exp_f32 v34, v34
    v_exp_f32 v35, v35
    v_exp_f32 v4, v4
    v_exp_f32 v5, v5
    s_waitcnt lgkmcnt(2)
    v_smfmac_f32_32x32x32_bf16 v[52:67], v[232:235], v[28:35], v249
    s_mov_b64 exec, s[40:41]
    ds_read_b128 v[232:235], v248 offset:2560
    s_mov_b64 exec, -1
    v_exp_f32 v6, v6
    v_exp_f32 v7, v7
    v_exp_f32 v8, v8
    v_exp_f32 v9, v9
    s_waitcnt lgkmcnt(2)
    v_mfma_f32_32x32x16_bf16 v[20:35], v[224:227], v[220:223], v[36:51]
    ds_read_b128 v[224:227], v3 offset:4096
    v_exp_f32 v10, v10
    v_exp_f32 v11, v11
    v_exp_f32 v12, v12
    v_exp_f32 v13, v13
    s_waitcnt lgkmcnt(2)
    v_smfmac_f32_32x32x32_bf16 v[52:67], v[228:231], v[4:11], v249
    s_mov_b64 exec, s[40:41]
    ds_read_b128 v[228:231], v248 offset:3072
    s_mov_b64 exec, -1
    v_exp_f32 v14, v14
    v_exp_f32 v15, v15
    v_exp_f32 v16, v16
    v_exp_f32 v17, v17
    s_waitcnt vmcnt(7)
    v_mfma_f32_32x32x16_bf16 v[84:99], v[200:203], v[212:215], v[84:99]
    buffer_load_dwordx4 v[200:203], v2, s[36:39], s73 offen offset:1024 sc1
    buffer_load_dwordx4 v[172:175], v2, s[36:39], s74 offen sc1
    s_add_u32 s74, s74, 16384
    v_exp_f32 v18, v18
    v_exp_f32 v19, v19
    v_exp_f32 v20, v20
    v_exp_f32 v21, v21
    s_waitcnt lgkmcnt(2)
    v_smfmac_f32_32x32x32_bf16 v[52:67], v[232:235], v[12:19], v249
    s_mov_b64 exec, s[40:41]
    ds_read_b128 v[232:235], v248 offset:3584
    s_mov_b64 exec, -1
    v_exp_f32 v22, v22
    v_exp_f32 v23, v23
    v_exp_f32 v24, v24
    v_exp_f32 v25, v25
    s_waitcnt lgkmcnt(2)
    v_mfma_f32_32x32x16_bf16 v[4:19], v[224:227], v[220:223], v[36:51]
    ds_read_b128 v[224:227], v3 offset:5120
    v_exp_f32 v26, v26
    v_exp_f32 v27, v27
    v_exp_f32 v28, v28
    v_exp_f32 v29, v29
    s_waitcnt lgkmcnt(2)
    v_smfmac_f32_32x32x32_bf16 v[52:67], v[228:231], v[20:27], v249
    s_mov_b64 exec, s[40:41]
    ds_read_b128 v[228:231], v248 offset:4096
    s_mov_b64 exec, -1
    v_exp_f32 v30, v30
    v_exp_f32 v31, v31
    v_exp_f32 v32, v32
    v_exp_f32 v33, v33
    s_waitcnt vmcnt(7)
    v_mfma_f32_32x32x16_bf16 v[100:115], v[204:207], v[212:215], v[100:115]
    buffer_load_dwordx4 v[204:207], v2, s[36:39], s73 offen offset:2048 sc1
    buffer_load_dwordx4 v[176:179], v2, s[36:39], s74 offen sc1
    s_add_u32 s74, s74, 16384
    v_exp_f32 v34, v34
    v_exp_f32 v35, v35
    v_add_u32 v3, 4096, v3
    v_add_u32 v248, 4096, v248
    v_exp_f32 v4, v4
    v_exp_f32 v5, v5
    s_waitcnt lgkmcnt(2)
    v_smfmac_f32_32x32x32_bf16 v[52:67], v[232:235], v[28:35], v249
    s_mov_b64 exec, s[40:41]
    ds_read_b128 v[232:235], v248 offset:512
    s_mov_b64 exec, -1
    v_exp_f32 v6, v6
    v_exp_f32 v7, v7
    v_exp_f32 v8, v8
    v_exp_f32 v9, v9
    s_waitcnt lgkmcnt(2)
    v_mfma_f32_32x32x16_bf16 v[20:35], v[224:227], v[220:223], v[36:51]
    ds_read_b128 v[224:227], v3 offset:2048
    v_exp_f32 v10, v10
    v_exp_f32 v11, v11
    v_exp_f32 v12, v12
    v_exp_f32 v13, v13
    s_waitcnt lgkmcnt(2)
    v_smfmac_f32_32x32x32_bf16 v[52:67], v[228:231], v[4:11], v249
    s_mov_b64 exec, s[40:41]
    ds_read_b128 v[228:231], v248 offset:1024
    s_mov_b64 exec, -1
    v_exp_f32 v14, v14
    v_exp_f32 v15, v15
    v_exp_f32 v16, v16
    v_exp_f32 v17, v17
    s_waitcnt vmcnt(7)
    v_mfma_f32_32x32x16_bf16 v[116:131], v[208:211], v[212:215], v[116:131]
    buffer_load_dwordx4 v[208:211], v2, s[36:39], s73 offen offset:3072 sc1
    s_add_u32 s73, s73, 16384
    buffer_load_dwordx4 v[180:183], v2, s[36:39], s74 offen sc1
    s_add_u32 s74, s74, 16384
    buffer_load_dwordx4 v[184:187], v2, s[36:39], s74 offen sc1
    s_add_u32 s74, s74, 16384
    v_exp_f32 v18, v18
    v_exp_f32 v19, v19
    v_exp_f32 v20, v20
    v_exp_f32 v21, v21
    s_waitcnt lgkmcnt(2)
    v_smfmac_f32_32x32x32_bf16 v[52:67], v[232:235], v[12:19], v249
    s_mov_b64 exec, s[40:41]
    ds_read_b128 v[232:235], v248 offset:1536
    s_mov_b64 exec, -1
    v_exp_f32 v22, v22
    v_exp_f32 v23, v23
    v_exp_f32 v24, v24
    s_waitcnt lgkmcnt(2)
    v_mfma_f32_32x32x16_bf16 v[4:19], v[224:227], v[220:223], v[36:51]
    ds_read_b128 v[224:227], v3 offset:3072
    v_exp_f32 v25, v25
    v_exp_f32 v26, v26
    v_exp_f32 v27, v27
    s_waitcnt vmcnt(8)
    v_mfma_f32_32x32x16_bf16 v[68:83], v[196:199], v[216:219], v[68:83]
    v_exp_f32 v28, v28
    v_exp_f32 v29, v29
    v_exp_f32 v30, v30
    s_waitcnt lgkmcnt(2)
    v_smfmac_f32_32x32x32_bf16 v[52:67], v[228:231], v[20:27], v249
    s_mov_b64 exec, s[40:41]
    ds_read_b128 v[228:231], v248 offset:2048
    s_mov_b64 exec, -1
    v_exp_f32 v31, v31
    v_exp_f32 v32, v32
    v_exp_f32 v33, v33
    s_waitcnt vmcnt(6)
    v_mfma_f32_32x32x16_bf16 v[84:99], v[200:203], v[216:219], v[84:99]
    buffer_load_dwordx4 v[188:191], v2, s[36:39], s74 offen sc1
    s_add_u32 s74, s74, 16384
    buffer_load_dwordx4 v[192:195], v2, s[36:39], s74 offen sc1
    s_add_u32 s74, s74, 16384
    v_exp_f32 v34, v34
    v_exp_f32 v35, v35
    v_exp_f32 v4, v4
    v_exp_f32 v5, v5
    s_waitcnt lgkmcnt(2)
    v_smfmac_f32_32x32x32_bf16 v[52:67], v[232:235], v[28:35], v249
    s_mov_b64 exec, s[40:41]
    ds_read_b128 v[232:235], v248 offset:2560
    s_mov_b64 exec, -1
    v_exp_f32 v6, v6
    v_exp_f32 v7, v7
    v_exp_f32 v8, v8
    v_exp_f32 v9, v9
    s_waitcnt lgkmcnt(2)
    v_mfma_f32_32x32x16_bf16 v[20:35], v[224:227], v[220:223], v[36:51]
    v_exp_f32 v10, v10
    v_exp_f32 v11, v11
    v_exp_f32 v12, v12
    v_exp_f32 v13, v13
    s_waitcnt lgkmcnt(1)
    v_smfmac_f32_32x32x32_bf16 v[52:67], v[228:231], v[4:11], v249
    s_mov_b64 exec, s[40:41]
    ds_read_b128 v[228:231], v248 offset:3072
    s_mov_b64 exec, -1
    v_exp_f32 v14, v14
    v_exp_f32 v15, v15
    v_exp_f32 v16, v16
    v_exp_f32 v17, v17
    s_waitcnt vmcnt(6)
    v_mfma_f32_32x32x16_bf16 v[100:115], v[204:207], v[216:219], v[100:115]
    buffer_load_dwordx4 v[236:239], v250, s[4:7], 0 offen
    v_and_b32 v244, 0x3ff, v250
    buffer_load_dwordx4 v[240:243], v244, s[28:31], 0 offen
    v_exp_f32 v18, v18
    v_exp_f32 v19, v19
    v_exp_f32 v20, v20
    v_exp_f32 v21, v21
    s_waitcnt lgkmcnt(1)
    v_smfmac_f32_32x32x32_bf16 v[52:67], v[232:235], v[12:19], v249
    s_mov_b64 exec, s[40:41]
    ds_read_b128 v[232:235], v248 offset:3584
    s_mov_b64 exec, -1
    v_exp_f32 v22, v22
    v_exp_f32 v23, v23
    v_exp_f32 v24, v24
    v_exp_f32 v25, v25
    v_exp_f32 v26, v26
    v_exp_f32 v27, v27
    v_exp_f32 v28, v28
    v_exp_f32 v29, v29
    s_waitcnt lgkmcnt(1)
    v_smfmac_f32_32x32x32_bf16 v[52:67], v[228:231], v[20:27], v249
    v_exp_f32 v30, v30
    v_exp_f32 v31, v31
    v_exp_f32 v32, v32
    v_exp_f32 v33, v33
    s_waitcnt vmcnt(6)
    v_mfma_f32_32x32x16_bf16 v[116:131], v[208:211], v[216:219], v[116:131]
    v_exp_f32 v34, v34
    v_exp_f32 v35, v35
    s_waitcnt lgkmcnt(0)
    s_nop 0
    v_smfmac_f32_32x32x32_bf16 v[52:67], v[232:235], v[28:35], v249
    v_mov_b32 v224, 65540
    ds_read_b32 v225, v224
    s_lshl_b32 s51, s42, 14
    s_cmp_ge_u32 s42, 3
    s_cselect_b32 s50, 24576, 0
    s_add_u32 s51, s51, s50
    v_and_b32 v4, 31, v0
    v_lshrrev_b32 v5, 5, v0
    v_and_b32 v6, 7, v0
    v_xor_b32 v5, v5, v6
    v_lshlrev_b32 v5, 4, v5
    v_lshl_add_u32 v4, v4, 9, v5
    v_add_u32 v4, s51, v4
    v_xor_b32 v5, 32, v4
    v_xor_b32 v6, 64, v4
    v_xor_b32 v7, 96, v4
    v_max3_f32 v245, abs(v52), abs(v53), abs(v54)
    v_max3_f32 v246, abs(v55), abs(v56), abs(v57)
    v_cmp_nle_f32 vcc, v60, s58
    v_max3_f32 v245, abs(v58), abs(v59), v245
    v_rcp_f32 v244, v60
    v_max_f32 v245, v245, v246
    v_cmp_nle_f32 s[50:51], v245, s59
    v_mul_f32 v52, v52, v244
    v_mul_f32 v53, v53, v244
    v_mul_f32 v54, v54, v244
    v_mul_f32 v55, v55, v244
    s_or_b64 vcc, vcc, s[50:51]
    s_cbranch_vccnz L_fallback
L_fbret:
    s_nop 0
    v_mul_f32 v56, v56, v244
    v_mul_f32 v57, v57, v244
    v_mul_f32 v58, v58, v244
    v_mul_f32 v59, v59, v244
    v_cvt_pk_bf16_f32 v60, v52, v53
    v_cvt_pk_bf16_f32 v61, v54, v55
    v_cvt_pk_bf16_f32 v62, v56, v57
    v_cvt_pk_bf16_f32 v63, v58, v59
    buffer_store_dwordx4 v[60:63], v2, s[36:39], s83 offen sc1
    s_mov_b32 s79, 0x800000
L_cnt_51:
    s_waitcnt lgkmcnt(0)
    v_readfirstlane_b32 s50, v225
    s_nop 0
    s_cmp_eq_u32 s50, 8
    s_cbranch_scc1 L_cntd_52
    ds_read_b32 v225, v224
    s_sub_u32 s79, s79, 1
    s_cbranch_scc0 L_cnt_51
L_cntd_52:
    s_lshl_b32 s56, s70, 15
    s_lshl_b32 s50, s42, 12
    s_add_u32 s56, s56, s50
    s_add_u32 s56, s56, 0x600000
    s_cmp_ge_u32 s42, 6
    s_cselect_b32 s51, 81920, 0
    s_add_u32 s50, s50, s51
    s_add_u32 s50, s50, 49152
    v_add_u32 v246, s50, v2
    s_mov_b32 s81, 0
    ds_write_b128 v4, v[68:71] offset:0
    ds_write_b128 v5, v[72:75] offset:0
    ds_write_b128 v6, v[76:79] offset:0
    ds_write_b128 v7, v[80:83] offset:0
    ds_write_b128 v4, v[84:87] offset:128
    ds_write_b128 v5, v[88:91] offset:128
    ds_write_b128 v6, v[92:95] offset:128
    ds_write_b128 v7, v[96:99] offset:128
    ds_write_b128 v4, v[100:103] offset:256
    ds_write_b128 v5, v[104:107] offset:256
    ds_write_b128 v6, v[108:111] offset:256
    ds_write_b128 v7, v[112:115] offset:256
    buffer_load_dwordx4 v[196:199], v2, s[36:39], s56 offen sc1
    buffer_load_dwordx4 v[200:203], v2, s[36:39], s56 offen offset:1024 sc1
    buffer_load_dwordx4 v[204:207], v2, s[36:39], s56 offen offset:2048 sc1
    buffer_load_dwordx4 v[208:211], v2, s[36:39], s56 offen offset:3072 sc1
    ds_write_b128 v4, v[116:119] offset:384
    ds_write_b128 v5, v[120:123] offset:384
    ds_write_b128 v6, v[124:127] offset:384
    ds_write_b128 v7, v[128:131] offset:384
    v_lshrrev_b32 v8, 4, v0
    s_lshl_b32 s50, s42, 2
    v_add_u32 v8, s50, v8
    v_and_b32 v9, 15, v0
    v_lshlrev_b32 v9, 1, v9
    v_and_b32 v10, 7, v8
    v_xor_b32 v9, v9, v10
    v_lshlrev_b32 v9, 4, v9
    v_lshl_add_u32 v8, v8, 9, v9
    v_xor_b32 v9, 16, v8
    v_add_u32 v10, 73728, v8
    v_add_u32 v11, 73728, v9
    v_add_u32 v12, 139264, v8
    v_add_u32 v13, 139264, v9
    s_waitcnt vmcnt(5)
    v_lshlrev_b32 v36, 16, v240
    v_and_b32 v37, 0xffff0000, v240
    v_lshlrev_b32 v38, 16, v241
    v_and_b32 v39, 0xffff0000, v241
    v_lshlrev_b32 v40, 16, v242
    v_and_b32 v41, 0xffff0000, v242
    v_lshlrev_b32 v42, 16, v243
    v_and_b32 v43, 0xffff0000, v243
    s_mov_b32 s58, 0xbfb8aa3b
    s_lshl_b32 s59, s44, 14
    s_lshl_b32 s50, s43, 7
    s_add_u32 s59, s59, s50
    s_mul_i32 s50, s44, 16384
    s_mul_i32 s51, s44, 98304
    s_add_u32 s50, s50, 49152
    s_add_u32 s51, s51, 57344
    v_add_u32 v244, s50, v2
    v_add_u32 v245, s51, v2
    s_waitcnt lgkmcnt(0)
    s_barrier
    ds_read_b128 v[68:71], v8 offset:0
    ds_read_b128 v[72:75], v9 offset:0
    ds_read_b128 v[76:79], v8 offset:16384
    ds_read_b128 v[80:83], v9 offset:16384
    ds_read_b128 v[84:87], v8 offset:32768
    ds_read_b128 v[88:91], v9 offset:32768
    ds_read_b128 v[92:95], v10 offset:0
    ds_read_b128 v[96:99], v11 offset:0
    ds_read_b128 v[100:103], v10 offset:16384
    ds_read_b128 v[104:107], v11 offset:16384
    ds_read_b128 v[108:111], v10 offset:32768
    ds_read_b128 v[112:115], v11 offset:32768
    ds_read_b128 v[116:119], v10 offset:49152
    ds_read_b128 v[120:123], v11 offset:49152
    ds_read_b128 v[124:127], v12 offset:0
    ds_read_b128 v[128:131], v13 offset:0
    s_waitcnt lgkmcnt(14)
    v_pk_add_f32 v[36:37], v[36:37], v[68:69]
    v_pk_add_f32 v[38:39], v[38:39], v[70:71]
    v_pk_add_f32 v[40:41], v[40:41], v[72:73]
    v_pk_add_f32 v[42:43], v[42:43], v[74:75]
    s_waitcnt lgkmcnt(12)
    v_pk_add_f32 v[36:37], v[36:37], v[76:77]
    v_pk_add_f32 v[38:39], v[38:39], v[78:79]
    v_pk_add_f32 v[40:41], v[40:41], v[80:81]
    v_pk_add_f32 v[42:43], v[42:43], v[82:83]
    s_waitcnt lgkmcnt(10)
    v_pk_add_f32 v[36:37], v[36:37], v[84:85]
    v_pk_add_f32 v[38:39], v[38:39], v[86:87]
    v_pk_add_f32 v[40:41], v[40:41], v[88:89]
    v_pk_add_f32 v[42:43], v[42:43], v[90:91]
    s_waitcnt lgkmcnt(8)
    v_pk_add_f32 v[36:37], v[36:37], v[92:93]
    v_pk_add_f32 v[38:39], v[38:39], v[94:95]
    v_pk_add_f32 v[40:41], v[40:41], v[96:97]
    v_pk_add_f32 v[42:43], v[42:43], v[98:99]
    s_waitcnt lgkmcnt(6)
    v_pk_add_f32 v[36:37], v[36:37], v[100:101]
    v_pk_add_f32 v[38:39], v[38:39], v[102:103]
    v_pk_add_f32 v[40:41], v[40:41], v[104:105]
    v_pk_add_f32 v[42:43], v[42:43], v[106:107]
    s_waitcnt lgkmcnt(4)
    v_pk_add_f32 v[36:37], v[36:37], v[108:109]
    v_pk_add_f32 v[38:39], v[38:39], v[110:111]
    v_pk_add_f32 v[40:41], v[40:41], v[112:113]
    v_pk_add_f32 v[42:43], v[42:43], v[114:115]
    s_waitcnt lgkmcnt(2)
    v_pk_add_f32 v[36:37], v[36:37], v[116:117]
    v_pk_add_f32 v[38:39], v[38:39], v[118:119]
    v_pk_add_f32 v[40:41], v[40:41], v[120:121]
    v_pk_add_f32 v[42:43], v[42:43], v[122:123]
    s_waitcnt lgkmcnt(0)
    v_pk_add_f32 v[36:37], v[36:37], v[124:125]
    v_pk_add_f32 v[38:39], v[38:39], v[126:127]
    v_pk_add_f32 v[40:41], v[40:41], v[128:129]
    v_pk_add_f32 v[42:43], v[42:43], v[130:131]
    s_cmp_lg_u32 s81, 0
    s_cbranch_scc1 L_f3_53
    s_mov_b32 s79, 0x40000
L_f3r_54:
    s_waitcnt vmcnt(0)
    v_max3_u32 v20, v196, v197, v198
    v_max3_u32 v21, v199, v200, v201
    v_max3_u32 v20, v202, v203, v20
    v_max3_u32 v21, v204, v205, v21
    v_max3_u32 v20, v206, v207, v20
    v_max3_u32 v21, v208, v209, v21
    v_max3_u32 v20, v210, v211, v20
    v_max_u32 v20, v20, v21
    v_cmp_eq_u32 vcc, -1, v20
    s_nop 0
    s_cbranch_vccz L_f3g_55
    buffer_load_dwordx4 v[196:199], v2, s[36:39], s56 offen sc1
    buffer_load_dwordx4 v[200:203], v2, s[36:39], s56 offen offset:1024 sc1
    buffer_load_dwordx4 v[204:207], v2, s[36:39], s56 offen offset:2048 sc1
    buffer_load_dwordx4 v[208:211], v2, s[36:39], s56 offen offset:3072 sc1
    s_sub_u32 s79, s79, 1
    s_cmp_lg_u32 s79, 0
    s_cbranch_scc1 L_f3r_54
    s_waitcnt vmcnt(0)
L_f3g_55:
    s_mov_b32 s81, 1
    ds_write_b128 v246, v[196:199] offset:0
    ds_write_b128 v246, v[200:203] offset:1024
    ds_write_b128 v246, v[204:207] offset:2048
    ds_write_b128 v246, v[208:211] offset:3072
L_f3_53:
    s_waitcnt lgkmcnt(0)
    s_barrier
    ds_read_b128 v[68:71], v244 offset:0
    ds_read_b128 v[72:75], v244 offset:1024
    ds_read_b128 v[76:79], v244 offset:2048
    ds_read_b128 v[80:83], v244 offset:3072
    ds_read_b128 v[84:87], v244 offset:4096
    ds_read_b128 v[88:91], v244 offset:5120
    ds_read_b128 v[92:95], v244 offset:6144
    ds_read_b128 v[96:99], v244 offset:7168
    ds_read_b128 v[100:103], v245 offset:0
    ds_read_b128 v[104:107], v245 offset:1024
    ds_read_b128 v[108:111], v245 offset:2048
    ds_read_b128 v[112:115], v245 offset:3072
    ds_read_b128 v[116:119], v245 offset:4096
    ds_read_b128 v[120:123], v245 offset:5120
    ds_read_b128 v[124:127], v245 offset:6144
    ds_read_b128 v[128:131], v245 offset:7168
    v_mul_f32 v44, s58, v36
    v_mul_f32 v45, s58, v37
    v_mul_f32 v46, s58, v38
    v_mul_f32 v47, s58, v39
    v_mul_f32 v48, s58, v40
    v_mul_f32 v49, s58, v41
    v_mul_f32 v50, s58, v42
    v_mul_f32 v51, s58, v43
    s_waitcnt lgkmcnt(15)
    v_mfma_f32_32x32x16_bf16 v[52:67], v[132:135], v[68:71], 0
    v_exp_f32 v44, v44
    v_exp_f32 v45, v45
    v_exp_f32 v46, v46
    s_waitcnt lgkmcnt(14)
    v_mfma_f32_32x32x16_bf16 v[52:67], v[136:139], v[72:75], v[52:67]
    v_exp_f32 v47, v47
    v_exp_f32 v48, v48
    v_exp_f32 v49, v49
    s_waitcnt lgkmcnt(13)
    v_mfma_f32_32x32x16_bf16 v[52:67], v[140:143], v[76:79], v[52:67]
    v_exp_f32 v50, v50
    v_exp_f32 v51, v51
    v_add_f32 v44, 1.0, v44
    s_waitcnt lgkmcnt(12)
    v_mfma_f32_32x32x16_bf16 v[52:67], v[144:147], v[80:83], v[52:67]
    v_add_f32 v45, 1.0, v45
    v_add_f32 v46, 1.0, v46
    v_add_f32 v47, 1.0, v47
    v_add_f32 v48, 1.0, v48
    v_add_f32 v49, 1.0, v49
    s_waitcnt lgkmcnt(11)
    v_mfma_f32_32x32x16_bf16 v[52:67], v[148:151], v[84:87], v[52:67]
    v_add_f32 v50, 1.0, v50
    v_add_f32 v51, 1.0, v51
    v_rcp_f32 v44, v44
    v_rcp_f32 v45, v45
    s_waitcnt lgkmcnt(10)
    v_mfma_f32_32x32x16_bf16 v[52:67], v[152:155], v[88:91], v[52:67]
    v_rcp_f32 v46, v46
    v_rcp_f32 v47, v47
    v_rcp_f32 v48, v48
    s_waitcnt lgkmcnt(9)
    v_mfma_f32_32x32x16_bf16 v[52:67], v[156:159], v[92:95], v[52:67]
    v_rcp_f32 v49, v49
    v_rcp_f32 v50, v50
    v_rcp_f32 v51, v51
    s_waitcnt lgkmcnt(8)
    v_mfma_f32_32x32x16_bf16 v[52:67], v[160:163], v[96:99], v[52:67]
    v_and_b32 v4, 31, v0
    v_lshrrev_b32 v5, 5, v0
    v_and_b32 v6, 7, v0
    v_xor_b32 v5, v5, v6
    v_lshlrev_b32 v5, 4, v5
    s_waitcnt lgkmcnt(7)
    v_mfma_f32_32x32x16_bf16 v[52:67], v[164:167], v[100:103], v[52:67]
    v_lshl_add_u32 v4, v4, 9, v5
    v_add_u32 v4, s59, v4
    v_xor_b32 v5, 32, v4
    v_xor_b32 v6, 64, v4
    v_xor_b32 v7, 96, v4
    s_waitcnt lgkmcnt(6)
    v_mfma_f32_32x32x16_bf16 v[52:67], v[168:171], v[104:107], v[52:67]
    v_mul_f32 v36, v36, v44
    v_mul_f32 v37, v37, v45
    v_mul_f32 v38, v38, v46
    v_mul_f32 v39, v39, v47
    v_mul_f32 v40, v40, v48
    s_waitcnt lgkmcnt(5)
    v_mfma_f32_32x32x16_bf16 v[52:67], v[172:175], v[108:111], v[52:67]
    v_mul_f32 v41, v41, v49
    v_mul_f32 v42, v42, v50
    v_mul_f32 v43, v43, v51
    v_lshlrev_b32 v44, 16, v236
    v_and_b32 v45, 0xffff0000, v236
    s_waitcnt lgkmcnt(4)
    v_mfma_f32_32x32x16_bf16 v[52:67], v[176:179], v[112:115], v[52:67]
    v_lshlrev_b32 v46, 16, v237
    v_and_b32 v47, 0xffff0000, v237
    v_lshlrev_b32 v48, 16, v238
    v_and_b32 v49, 0xffff0000, v238
    v_lshlrev_b32 v50, 16, v239
    s_waitcnt lgkmcnt(3)
    v_mfma_f32_32x32x16_bf16 v[52:67], v[180:183], v[116:119], v[52:67]
    v_and_b32 v51, 0xffff0000, v239
    s_waitcnt lgkmcnt(2)
    v_mfma_f32_32x32x16_bf16 v[52:67], v[184:187], v[120:123], v[52:67]
    s_waitcnt lgkmcnt(1)
    v_mfma_f32_32x32x16_bf16 v[52:67], v[188:191], v[124:127], v[52:67]
    s_waitcnt lgkmcnt(0)
    v_mfma_f32_32x32x16_bf16 v[52:67], v[192:195], v[128:131], v[52:67]
    s_nop 11
    ds_write_b128 v4, v[52:55] offset:0
    ds_write_b128 v5, v[56:59] offset:0
    ds_write_b128 v6, v[60:63] offset:0
    ds_write_b128 v7, v[64:67] offset:0
    s_waitcnt lgkmcnt(0)
    s_barrier
    ds_read_b128 v[68:71], v8 offset:0
    ds_read_b128 v[72:75], v9 offset:0
    ds_read_b128 v[76:79], v8 offset:16384
    ds_read_b128 v[80:83], v9 offset:16384
    s_waitcnt lgkmcnt(0)
    v_pk_add_f32 v[68:69], v[68:69], v[76:77]
    v_pk_add_f32 v[70:71], v[70:71], v[78:79]
    v_pk_add_f32 v[72:73], v[72:73], v[80:81]
    v_pk_add_f32 v[74:75], v[74:75], v[82:83]
    v_pk_fma_f32 v[68:69], v[68:69], v[36:37], v[44:45]
    v_pk_fma_f32 v[70:71], v[70:71], v[38:39], v[46:47]
    v_pk_fma_f32 v[72:73], v[72:73], v[40:41], v[48:49]
    v_pk_fma_f32 v[74:75], v[74:75], v[42:43], v[50:51]
    v_cvt_pk_bf16_f32 v76, v68, v69
    v_cvt_pk_bf16_f32 v77, v70, v71
    v_cvt_pk_bf16_f32 v78, v72, v73
    v_cvt_pk_bf16_f32 v79, v74, v75
    buffer_store_dwordx4 v[76:79], v250, s[32:35], 0 offen
L_exit:
    s_endpgm
L_fallback:
    s_waitcnt lgkmcnt(0)
    s_lshl_b32 s54, s68, 16
    s_add_u32 s52, s54, 0x200000
    v_mov_b32 v244, 0xff800000
    s_mov_b32 s76, 64
L_fb1_56:
    buffer_load_dwordx4 v[224:227], v2, s[36:39], s52 offen sc1
    s_add_u32 s52, s52, 1024
    s_waitcnt vmcnt(0)
    v_mfma_f32_32x32x16_bf16 v[20:35], v[224:227], v[220:223], 0
    s_nop 11
    v_max3_f32 v244, v20, v21, v244
    v_max3_f32 v244, v22, v23, v244
    v_max3_f32 v244, v24, v25, v244
    v_max3_f32 v244, v26, v27, v244
    v_max3_f32 v244, v28, v29, v244
    v_max3_f32 v244, v30, v31, v244
    v_max3_f32 v244, v32, v33, v244
    v_max3_f32 v244, v34, v35, v244
    s_sub_u32 s76, s76, 1
    s_cmp_lg_u32 s76, 0
    s_cbranch_scc1 L_fb1_56
    v_mov_b32 v245, v244
    s_nop 1
    v_permlane32_swap_b32 v244, v245
    v_max_f32 v244, v244, v245
    v_sub_f32 v36, 0, v244
    v_mov_b32 v37, v36
    v_mov_b32 v38, v36
    v_mov_b32 v39, v36
    v_mov_b32 v40, v36
    v_mov_b32 v41, v36
    v_mov_b32 v42, v36
    v_mov_b32 v43, v36
    v_mov_b32 v44, v36
    v_mov_b32 v45, v36
    v_mov_b32 v46, v36
    v_mov_b32 v47, v36
    v_mov_b32 v48, v36
    v_mov_b32 v49, v36
    v_mov_b32 v50, v36
    v_mov_b32 v51, v36
    v_mov_b32 v52, 0
    v_mov_b32 v53, 0
    v_mov_b32 v54, 0
    v_mov_b32 v55, 0
    v_mov_b32 v56, 0
    v_mov_b32 v57, 0
    v_mov_b32 v58, 0
    v_mov_b32 v59, 0
    v_mov_b32 v60, 0
    v_mov_b32 v61, 0
    v_mov_b32 v62, 0
    v_mov_b32 v63, 0
    v_mov_b32 v64, 0
    v_mov_b32 v65, 0
    v_mov_b32 v66, 0
    v_mov_b32 v67, 0
    v_and_b32 v244, 15, v0
    v_lshrrev_b32 v245, 5, v0
    v_lshlrev_b32 v245, 8, v245
    v_lshl_add_u32 v244, v244, 4, v245
    s_add_u32 s52, s54, 0x200000
    s_add_u32 s53, s54, 0x400000
    s_mov_b32 s76, 64
L_fb2_57:
    buffer_load_dwordx4 v[224:227], v2, s[36:39], s52 offen sc1
    s_mov_b32 exec_lo, 0xffff
    s_mov_b32 exec_hi, 0xffff
    buffer_load_dwordx4 v[228:231], v244, s[36:39], s53 offen sc1
    buffer_load_dwordx4 v[232:235], v244, s[36:39], s53 offen offset:512 sc1
    s_mov_b64 exec, -1
    s_add_u32 s52, s52, 1024
    s_add_u32 s53, s53, 1024
    s_waitcnt vmcnt(0)
    v_mfma_f32_32x32x16_bf16 v[20:35], v[224:227], v[220:223], v[36:51]
    s_nop 11
    v_exp_f32 v20, v20
    v_exp_f32 v21, v21
    v_exp_f32 v22, v22
    v_exp_f32 v23, v23
    v_exp_f32 v24, v24
    v_exp_f32 v25, v25
    v_exp_f32 v26, v26
    v_exp_f32 v27, v27
    v_exp_f32 v28, v28
    v_exp_f32 v29, v29
    v_exp_f32 v30, v30
    v_exp_f32 v31, v31
    v_exp_f32 v32, v32
    v_exp_f32 v33, v33
    v_exp_f32 v34, v34
    v_exp_f32 v35, v35
    v_smfmac_f32_32x32x32_bf16 v[52:67], v[228:231], v[20:27], v249
    s_nop 0
    v_smfmac_f32_32x32x32_bf16 v[52:67], v[232:235], v[28:35], v249
    s_sub_u32 s76, s76, 1
    s_cmp_lg_u32 s76, 0
    s_cbranch_scc1 L_fb2_57
    v_mov_b32 v224, 65540
    ds_read_b32 v225, v224
    s_nop 6
    v_rcp_f32 v244, v60
    s_nop 0
    v_mul_f32 v52, v52, v244
    v_mul_f32 v53, v53, v244
    v_mul_f32 v54, v54, v244
    v_mul_f32 v55, v55, v244
    s_branch L_fbret
L_codeend:
.section .rodata,"a"
.p2align 6
.amdhsa_kernel recurrent_scan__mha_block__mixer_channel_mlp__prompt_kernel
  .amdhsa_next_free_vgpr 256
  .amdhsa_next_free_sgpr 102
  .amdhsa_accum_offset 256
  .amdhsa_group_segment_fixed_size 0
  .amdhsa_kernarg_size 88
  .amdhsa_user_sgpr_count 2
  .amdhsa_user_sgpr_kernarg_segment_ptr 1
  .amdhsa_system_sgpr_workgroup_id_x 1
.end_amdhsa_kernel
```
